```python
import torch

def _softmax(x, axis=-1):
    return torch.softmax(x, dim=axis)
def _gelu(x):
    return torch.nn.functional.gelu(x, approximate="tanh")
def _silu(x):
    return torch.nn.functional.silu(x)
def _sigmoid(x):
    return torch.sigmoid(x)
def _layernorm(x, axis=-1, eps=1e-5):
    m = x.mean(dim=axis, keepdim=True)
    v = x.var(dim=axis, keepdim=True, unbiased=False)
    return (x - m) / torch.sqrt(v + eps)
def _scatter_add(tgt, idx, src, axis=0):
    return tgt.clone().index_add_(axis, idx, src)
def _segment_sum(src, seg, n):
    out = torch.zeros((n,) + src.shape[1:], dtype=src.dtype)
    return out.index_add_(0, seg, src)
def _pad(x, pw):
    flat = tuple(v for pair in reversed(pw) for v in pair)
    return torch.nn.functional.pad(x, flat)

kernel_name = 'parallel_sum__gqa_block_cached__geglu_ffn__decode'

def setup_inputs():

    _w = (lambda a: (lambda t: t.to(torch.bfloat16) if t.is_floating_point() else t)(torch.as_tensor(a)))
    def _A_setup():
        B, Sq, D = 2, 1, 640
        Hq, Hkv, Sk, Dh = 32, 32, 4096, 128
        assert Hq % Hkv == 0, (Hq, Hkv)
        return {
            "x": _w((lambda *s: torch.randn(*s, dtype=torch.bfloat16) * 0.05)(B, Sq, D)),
            "k_cache": _w((lambda *s: torch.randn(*s, dtype=torch.bfloat16) * 3.2)(B, Hkv, Sk, Dh)),
            "v_cache": _w((lambda *s: torch.randn(*s, dtype=torch.bfloat16) * 1.6)(B, Hkv, Sk, Dh)),
            "wq": _w((lambda *s: torch.randn(*s, dtype=torch.bfloat16) * 3.2)(D, Hq * Dh) * (D ** -0.5)),
            "wo": _w((lambda *s: torch.randn(*s, dtype=torch.bfloat16) * 1.6)(Hq * Dh, D) * ((Hq * Dh) ** -0.5)),
        }
    _A_in = _A_setup()

    def _B_setup():
        B, S, D, F = 2, 1, 640, 1728
        return {
            "x": _w((lambda *s: torch.randn(*s, dtype=torch.bfloat16) * 0.05)(B, S, D)),
            "w_gate": _w((lambda *s: torch.randn(*s, dtype=torch.bfloat16) * 0.05)(D, F)),
            "w_up": _w((lambda *s: torch.randn(*s, dtype=torch.bfloat16) * 0.05)(D, F)),
            "w_down": _w((lambda *s: torch.randn(*s, dtype=torch.bfloat16) * 0.05)(F, D)),
        }
    _B_in = _B_setup()

    return {
        "A_x": _A_in["x"],
        "A_k_cache": _A_in["k_cache"],
        "A_v_cache": _A_in["v_cache"],
        "A_wq": _A_in["wq"],
        "A_wo": _A_in["wo"],
        "B_x": _B_in["x"],
        "B_w_gate": _B_in["w_gate"],
        "B_w_up": _B_in["w_up"],
        "B_w_down": _B_in["w_down"],
    }

def reference(A_x, A_k_cache, A_v_cache, A_wq, A_wo, B_x, B_w_gate, B_w_up, B_w_down):
    def _A_ref(x, k_cache, v_cache, wq, wo):
        B, Sq, D = x.shape
        Hq, Dh = 32, 128
        Hkv = k_cache.shape[1]
        rep = Hq // Hkv
        q = (lambda x, *d: x.permute(*d))((x @ wq).reshape(B, Sq, Hq, Dh), 0, 2, 1, 3)
        k = (lambda x, n, axis: torch.repeat_interleave(x, n, dim=axis))(k_cache, rep, axis=1)
        v = (lambda x, n, axis: torch.repeat_interleave(x, n, dim=axis))(v_cache, rep, axis=1)
        scores = torch.einsum("bhqd,bhkd->bhqk", q, k) * (Dh ** -0.5)
        p = _softmax(scores, axis=-1)
        o = torch.einsum("bhqk,bhkd->bhqd", p, v)
        return (lambda x, *d: x.permute(*d))(o, 0, 2, 1, 3).reshape(B, Sq, Hq * Dh) @ wo

    def _B_ref(x, w_gate, w_up, w_down):
        return (_gelu(x @ w_gate) * (x @ w_up)) @ w_down

    x = A_x
    xn = _layernorm(x, axis=-1)
    return x + _A_ref(xn, A_k_cache, A_v_cache, A_wq, A_wo) + _B_ref(xn, B_w_gate, B_w_up, B_w_down)
```

```asm
; @launch grid=(256,1,1) block=(1024,1,1) lds=10880
.amdgcn_target "amdgcn-amd-amdhsa--gfx950"
.text
.globl parallel_sum__gqa_block_cached__geglu_ffn__decode_kernel
.p2align 8
.type parallel_sum__gqa_block_cached__geglu_ffn__decode_kernel,@function
parallel_sum__gqa_block_cached__geglu_ffn__decode_kernel:
    s_cmp_ge_u32 s2, 256
    s_cbranch_scc1 L_end
    s_load_dwordx16 s[72:87], s[0:1], 0
    s_load_dwordx8 s[88:95], s[0:1], 64
    v_lshrrev_b32 v2, 6, v0
    s_lshr_b32 s4, s2, 3
    v_readfirstlane_b32 s3, v2
    s_and_b32 s5, s4, 0x18
    s_and_b32 s55, s2, 0x27
    s_or_b32 s55, s55, s5
    s_and_b32 s67, s4, 3
    s_and_b32 s5, s2, 7
    s_bfe_u32 s40, s2, 0x10006
    s_lshl1_add_u32 s40, s5, s40
    s_and_b32 s5, s4, 0x10
    s_or_b32 s40, s40, s5
    s_and_b32 s5, s2, 0x20
    s_or_b32 s41, s40, s5
    s_and_b32 s66, s55, 31
    s_mov_b32 s96, s66
    s_cmp_lt_u32 s66, 27
    s_cselect_b32 s5, 4, 2
    s_cmp_ge_u32 s3, s5
    s_cbranch_scc1 L_bentry
    s_setprio 3
    v_and_b32 v1, 63, v0
    s_and_b32 s68, s4, 7
    s_lshl_b32 s59, s96, 7
    s_lshl1_add_u32 s60, s40, s3
    s_lshl_b32 s60, s60, 7
    s_cmp_lt_u32 s3, 2
    s_movk_i32 s63, 3456
    s_cselect_b32 s63, 8192, s63
    s_cselect_b32 s62, s60, s59
    s_mul_i32 s22, s63, 640
    s_mov_b32 s23, 0x20000
    s_mul_i32 s60, s68, 80
    s_mul_i32 s59, s60, s63
    s_add_u32 s62, s62, s59
    s_lshl_b32 s60, s60, 1
    s_movk_i32 s10, 2560
    s_mov_b32 s11, 0x20000
    v_and_b32 v30, 7, v1
    v_and_b32 v48, 31, v1
    v_lshrrev_b32 v49, 5, v1
    v_mul_u32_u24 v49, 1280, v49
    v_lshl_add_u32 v52, v48, 3, v49
    v_lshl_add_u32 v48, v48, 4, v49
    v_lshrrev_b32 v49, 3, v1
    v_mul_u32_u24 v50, 20, v49
    s_mul_i32 s61, s63, 10
    v_mul_u32_u24 v51, s61, v49
    v_lshl_add_u32 v51, v30, 4, v51
    v_cmp_gt_u32 vcc, 24, v0
    v_lshlrev_b32 v6, 2, v0
    v_mov_b32 v7, 0
    s_mov_b64 exec, vcc
    ds_write_b32 v6, v7 offset:10720
    s_mov_b64 exec, -1
    s_waitcnt lgkmcnt(0)
    s_mov_b64 s[8:9], s[72:73]
    buffer_load_dwordx4 v[104:107], v48, s[8:11], 0 offen
    buffer_load_dwordx4 v[108:111], v48, s[8:11], 0 offen offset:512
    buffer_load_dwordx2 v[112:113], v52, s[8:11], 0 offen offset:1024
    s_cmp_eq_u32 s3, 2
    s_cselect_b64 s[20:21], s[84:85], s[86:87]
    s_cmp_lt_u32 s3, 2
    s_cselect_b64 s[20:21], s[78:79], s[20:21]
    buffer_load_dwordx4 v[114:117], v50, s[8:11], s60 offen offset:0
    buffer_load_dword v118, v50, s[8:11], s60 offen offset:16
    buffer_load_dwordx4 v[120:123], v50, s[8:11], s60 offen offset:1280
    buffer_load_dword v124, v50, s[8:11], s60 offen offset:1296
    buffer_load_dwordx4 v[64:67], v51, s[20:23], s62 offen nt
    s_add_u32 s62, s62, s63
    buffer_load_dwordx4 v[68:71], v51, s[20:23], s62 offen nt
    s_add_u32 s62, s62, s63
    buffer_load_dwordx4 v[72:75], v51, s[20:23], s62 offen nt
    s_add_u32 s62, s62, s63
    buffer_load_dwordx4 v[76:79], v51, s[20:23], s62 offen nt
    s_add_u32 s62, s62, s63
    buffer_load_dwordx4 v[80:83], v51, s[20:23], s62 offen nt
    s_add_u32 s62, s62, s63
    buffer_load_dwordx4 v[84:87], v51, s[20:23], s62 offen nt
    s_add_u32 s62, s62, s63
    buffer_load_dwordx4 v[88:91], v51, s[20:23], s62 offen nt
    s_add_u32 s62, s62, s63
    buffer_load_dwordx4 v[92:95], v51, s[20:23], s62 offen nt
    s_add_u32 s62, s62, s63
    buffer_load_dwordx4 v[96:99], v51, s[20:23], s62 offen nt
    s_add_u32 s62, s62, s63
    buffer_load_dwordx4 v[100:103], v51, s[20:23], s62 offen nt
    s_barrier
    s_load_dword s69, s[94:95], 688128
    s_lshl_b32 s49, s41, 20
    s_lshl_b32 s5, s67, 14
    s_or_b32 s49, s49, s5
    v_and_b32 v4, 63, v0
    v_lshlrev_b32 v4, 4, v4
    v_and_b32 v6, 0xc0, v0
    v_lshl_or_b32 v4, v6, 6, v4
    v_and_b32 v6, 0x300, v0
    v_lshl_or_b32 v4, v6, 10, v4
    s_mov_b32 s14, 67108864
    s_mov_b32 s15, 0x20000
    s_mov_b64 s[12:13], s[74:75]
    s_mov_b32 s46, 0xffff0000
    v_lshrrev_b32 v2, 4, v1
    v_and_b32 v3, 15, v1
    s_lshr_b32 s54, s55, 5
    s_mov_b64 s[36:37], s[94:95]
    s_mov_b32 s38, 268435456
    s_mov_b32 s39, 0x20000
    s_mov_b64 s[28:29], s[88:89]
    s_mov_b32 s31, 0x20000
    s_mov_b64 s[16:17], s[76:77]
    s_mov_b32 s18, 67108864
    s_mov_b32 s19, 0x20000
    s_mov_b64 s[24:25], s[80:81]
    s_mov_b32 s26, 5242880
    s_mov_b32 s27, 0x20000
    s_mov_b64 s[32:33], s[90:91]
    s_mov_b32 s34, 2560
    s_mov_b32 s35, 0x20000
    s_lshl2_add_u32 s58, s66, s67
    s_sub_u32 s56, s58, 108
    s_cselect_b32 s56, -1, s56
    s_cselect_b32 s60, 2211840, 0
    s_lshl2_add_u32 s59, s96, s67
    s_mul_i32 s65, s59, 20480
    s_lshl_b32 s59, s3, 7
    s_add_u32 s65, s65, s59
    s_cmp_lt_u32 s3, 10
    s_cselect_b32 s30, s60, 0
    v_mul_u32_u24 v31, 5120, v2
    v_lshl_add_u32 v31, v3, 3, v31
    s_mov_b32 s71, 0x40000
    s_mov_b32 s44, 0x05040100
    s_mov_b32 s45, 0x07060302
    s_movk_i32 s42, 0xff00
    s_lshl_b32 s70, s66, 14
    s_add_u32 s70, s70, 2097152
    s_waitcnt vmcnt(14)
    v_lshlrev_b32 v32, 16, v104
    v_and_b32 v104, s46, v104
    v_lshlrev_b32 v33, 16, v105
    v_and_b32 v105, s46, v105
    v_lshlrev_b32 v34, 16, v106
    v_and_b32 v106, s46, v106
    v_lshlrev_b32 v35, 16, v107
    v_and_b32 v107, s46, v107
    v_lshlrev_b32 v36, 16, v108
    v_and_b32 v108, s46, v108
    v_lshlrev_b32 v37, 16, v109
    v_and_b32 v109, s46, v109
    v_lshlrev_b32 v38, 16, v110
    v_and_b32 v110, s46, v110
    v_lshlrev_b32 v39, 16, v111
    v_and_b32 v111, s46, v111
    v_lshlrev_b32 v40, 16, v112
    v_and_b32 v112, s46, v112
    v_lshlrev_b32 v41, 16, v113
    v_and_b32 v113, s46, v113
    v_add_f32 v52, v32, v33
    v_add_f32 v53, v34, v35
    v_add_f32 v54, v36, v37
    v_add_f32 v55, v38, v39
    v_add_f32 v52, v52, v40
    v_add_f32 v53, v53, v41
    v_add_f32 v54, v54, v104
    v_add_f32 v55, v55, v105
    v_add_f32 v52, v52, v106
    v_add_f32 v53, v53, v107
    v_add_f32 v54, v54, v108
    v_add_f32 v55, v55, v109
    v_add_f32 v52, v52, v110
    v_add_f32 v53, v53, v111
    v_add_f32 v54, v54, v112
    v_add_f32 v55, v55, v113
    v_add_f32 v52, v52, v53
    v_add_f32 v54, v54, v55
    v_add_f32 v52, v52, v54
    s_nop 1
    v_add_f32_dpp v52, v52, v52 row_ror:8 row_mask:0xf bank_mask:0xf
    s_nop 1
    v_add_f32_dpp v52, v52, v52 row_ror:4 row_mask:0xf bank_mask:0xf
    s_nop 1
    v_add_f32_dpp v52, v52, v52 row_ror:2 row_mask:0xf bank_mask:0xf
    s_nop 1
    v_add_f32_dpp v52, v52, v52 row_ror:1 row_mask:0xf bank_mask:0xf
    v_mov_b32 v54, v52
    s_nop 1
    v_permlane16_swap_b32 v52, v54
    v_add_f32 v52, v52, v54
    v_mul_f32 v52, 0x3acccccd, v52
    v_sub_f32 v32, v32, v52
    v_sub_f32 v33, v33, v52
    v_sub_f32 v34, v34, v52
    v_sub_f32 v35, v35, v52
    v_sub_f32 v36, v36, v52
    v_sub_f32 v37, v37, v52
    v_sub_f32 v38, v38, v52
    v_sub_f32 v39, v39, v52
    v_sub_f32 v40, v40, v52
    v_sub_f32 v41, v41, v52
    v_sub_f32 v104, v104, v52
    v_sub_f32 v105, v105, v52
    v_sub_f32 v106, v106, v52
    v_sub_f32 v107, v107, v52
    v_sub_f32 v108, v108, v52
    v_sub_f32 v109, v109, v52
    v_sub_f32 v110, v110, v52
    v_sub_f32 v111, v111, v52
    v_sub_f32 v112, v112, v52
    v_sub_f32 v113, v113, v52
    v_mul_f32 v53, v32, v32
    v_mul_f32 v54, v33, v33
    v_mul_f32 v55, v34, v34
    v_fmac_f32 v53, v35, v35
    v_fmac_f32 v54, v36, v36
    v_fmac_f32 v55, v37, v37
    v_fmac_f32 v53, v38, v38
    v_fmac_f32 v54, v39, v39
    v_fmac_f32 v55, v40, v40
    v_fmac_f32 v53, v41, v41
    v_fmac_f32 v54, v104, v104
    v_fmac_f32 v55, v105, v105
    v_fmac_f32 v53, v106, v106
    v_fmac_f32 v54, v107, v107
    v_fmac_f32 v55, v108, v108
    v_fmac_f32 v53, v109, v109
    v_fmac_f32 v54, v110, v110
    v_fmac_f32 v55, v111, v111
    v_fmac_f32 v53, v112, v112
    v_fmac_f32 v54, v113, v113
    v_add_f32 v53, v53, v54
    v_add_f32 v53, v53, v55
    s_nop 1
    v_add_f32_dpp v53, v53, v53 row_ror:8 row_mask:0xf bank_mask:0xf
    s_nop 1
    v_add_f32_dpp v53, v53, v53 row_ror:4 row_mask:0xf bank_mask:0xf
    s_nop 1
    v_add_f32_dpp v53, v53, v53 row_ror:2 row_mask:0xf bank_mask:0xf
    s_nop 1
    v_add_f32_dpp v53, v53, v53 row_ror:1 row_mask:0xf bank_mask:0xf
    v_mov_b32 v54, v53
    s_nop 1
    v_permlane16_swap_b32 v53, v54
    v_add_f32 v53, v53, v54
    v_mul_f32 v53, 0x3acccccd, v53
    v_cvt_pk_bf16_f32 v52, v52, v52
    v_lshlrev_b32 v52, 16, v52
    v_cvt_pk_bf16_f32 v53, v53, v53
    v_lshlrev_b32 v53, 16, v53
    v_add_f32 v53, 0x3727c5ac, v53
    v_cvt_pk_bf16_f32 v53, v53, v53
    v_lshlrev_b32 v53, 16, v53
    v_sqrt_f32 v53, v53
    s_nop 0
    v_cvt_pk_bf16_f32 v53, v53, v53
    v_lshlrev_b32 v53, 16, v53
    v_rcp_f32 v53, v53
    v_mov_b32 v54, v52
    v_mov_b32 v55, v53
    s_nop 0
    v_permlane32_swap_b32 v52, v54
    v_permlane32_swap_b32 v53, v55
    s_waitcnt vmcnt(10)
    v_lshlrev_b32 v32, 16, v114
    v_and_b32 v114, s46, v114
    v_lshlrev_b32 v33, 16, v115
    v_and_b32 v115, s46, v115
    v_lshlrev_b32 v34, 16, v116
    v_and_b32 v116, s46, v116
    v_lshlrev_b32 v35, 16, v117
    v_and_b32 v117, s46, v117
    v_lshlrev_b32 v36, 16, v118
    v_and_b32 v118, s46, v118
    v_lshlrev_b32 v37, 16, v120
    v_and_b32 v120, s46, v120
    v_lshlrev_b32 v38, 16, v121
    v_and_b32 v121, s46, v121
    v_lshlrev_b32 v39, 16, v122
    v_and_b32 v122, s46, v122
    v_lshlrev_b32 v40, 16, v123
    v_and_b32 v123, s46, v123
    v_lshlrev_b32 v41, 16, v124
    v_and_b32 v124, s46, v124
    v_sub_f32 v32, v32, v52
    v_sub_f32 v114, v114, v52
    v_sub_f32 v33, v33, v52
    v_sub_f32 v115, v115, v52
    v_sub_f32 v34, v34, v52
    v_sub_f32 v116, v116, v52
    v_sub_f32 v35, v35, v52
    v_sub_f32 v117, v117, v52
    v_sub_f32 v36, v36, v52
    v_sub_f32 v118, v118, v52
    v_sub_f32 v37, v37, v54
    v_sub_f32 v120, v120, v54
    v_sub_f32 v38, v38, v54
    v_sub_f32 v121, v121, v54
    v_sub_f32 v39, v39, v54
    v_sub_f32 v122, v122, v54
    v_sub_f32 v40, v40, v54
    v_sub_f32 v123, v123, v54
    v_sub_f32 v41, v41, v54
    v_sub_f32 v124, v124, v54
    v_cvt_pk_bf16_f32 v114, v32, v114
    v_cvt_pk_bf16_f32 v115, v33, v115
    v_cvt_pk_bf16_f32 v116, v34, v116
    v_cvt_pk_bf16_f32 v117, v35, v117
    v_cvt_pk_bf16_f32 v118, v36, v118
    v_cvt_pk_bf16_f32 v120, v37, v120
    v_cvt_pk_bf16_f32 v121, v38, v121
    v_cvt_pk_bf16_f32 v122, v39, v122
    v_cvt_pk_bf16_f32 v123, v40, v123
    v_cvt_pk_bf16_f32 v124, v41, v124
    v_lshlrev_b32 v32, 16, v114
    v_and_b32 v114, s46, v114
    v_lshlrev_b32 v33, 16, v115
    v_and_b32 v115, s46, v115
    v_lshlrev_b32 v34, 16, v116
    v_and_b32 v116, s46, v116
    v_lshlrev_b32 v35, 16, v117
    v_and_b32 v117, s46, v117
    v_lshlrev_b32 v36, 16, v118
    v_and_b32 v118, s46, v118
    v_lshlrev_b32 v37, 16, v120
    v_and_b32 v120, s46, v120
    v_lshlrev_b32 v38, 16, v121
    v_and_b32 v121, s46, v121
    v_lshlrev_b32 v39, 16, v122
    v_and_b32 v122, s46, v122
    v_lshlrev_b32 v40, 16, v123
    v_and_b32 v123, s46, v123
    v_lshlrev_b32 v41, 16, v124
    v_and_b32 v124, s46, v124
    v_mul_f32 v32, v32, v53
    v_mul_f32 v114, v114, v53
    v_mul_f32 v33, v33, v53
    v_mul_f32 v115, v115, v53
    v_mul_f32 v34, v34, v53
    v_mul_f32 v116, v116, v53
    v_mul_f32 v35, v35, v53
    v_mul_f32 v117, v117, v53
    v_mul_f32 v36, v36, v53
    v_mul_f32 v118, v118, v53
    v_mul_f32 v37, v37, v55
    v_mul_f32 v120, v120, v55
    v_mul_f32 v38, v38, v55
    v_mul_f32 v121, v121, v55
    v_mul_f32 v39, v39, v55
    v_mul_f32 v122, v122, v55
    v_mul_f32 v40, v40, v55
    v_mul_f32 v123, v123, v55
    v_mul_f32 v41, v41, v55
    v_mul_f32 v124, v124, v55
    v_cvt_pk_bf16_f32 v114, v32, v114
    v_cvt_pk_bf16_f32 v115, v33, v115
    v_cvt_pk_bf16_f32 v116, v34, v116
    v_cvt_pk_bf16_f32 v117, v35, v117
    v_cvt_pk_bf16_f32 v118, v36, v118
    v_cvt_pk_bf16_f32 v120, v37, v120
    v_cvt_pk_bf16_f32 v121, v38, v121
    v_cvt_pk_bf16_f32 v122, v39, v122
    v_cvt_pk_bf16_f32 v123, v40, v123
    v_cvt_pk_bf16_f32 v124, v41, v124
    s_waitcnt lgkmcnt(0)
    s_mul_i32 s69, s69, 0x9E3779B1
    s_add_u32 s69, s69, 0x7F4A7C15
    s_and_b32 s43, s69, 0xff
    v_lshrrev_b32 v48, 5, v1
    v_lshlrev_b32 v48, 10, v48
    v_lshl_add_u32 v48, v30, 5, v48
    v_and_b32 v49, 16, v1
    v_add_u32 v48, v49, v48
    s_lshl_b32 s59, s68, 11
    s_lshl_b32 s60, s3, 8
    s_add_u32 s59, s59, s60
    s_add_u32 s59, s59, s70
    v_mov_b32 v50, s43
    s_waitcnt vmcnt(8)
    v_perm_b32 v56, v68, v64, s44
    v_perm_b32 v68, v68, v64, s45
    v_perm_b32 v57, v69, v65, s44
    v_perm_b32 v69, v69, v65, s45
    v_perm_b32 v58, v70, v66, s44
    v_perm_b32 v70, v70, v66, s45
    v_perm_b32 v59, v71, v67, s44
    v_perm_b32 v71, v71, v67, s45
    v_dot2_f32_bf16 v32, v56, v114, 0
    v_dot2_f32_bf16 v33, v68, v114, 0
    v_dot2_f32_bf16 v34, v57, v114, 0
    v_dot2_f32_bf16 v35, v69, v114, 0
    v_dot2_f32_bf16 v36, v58, v114, 0
    v_dot2_f32_bf16 v37, v70, v114, 0
    v_dot2_f32_bf16 v38, v59, v114, 0
    v_dot2_f32_bf16 v39, v71, v114, 0
    v_dot2_f32_bf16 v40, v56, v120, 0
    v_dot2_f32_bf16 v41, v68, v120, 0
    v_dot2_f32_bf16 v42, v57, v120, 0
    v_dot2_f32_bf16 v43, v69, v120, 0
    v_dot2_f32_bf16 v44, v58, v120, 0
    v_dot2_f32_bf16 v45, v70, v120, 0
    v_dot2_f32_bf16 v46, v59, v120, 0
    v_dot2_f32_bf16 v47, v71, v120, 0
    s_waitcnt vmcnt(6)
    v_perm_b32 v56, v76, v72, s44
    v_perm_b32 v76, v76, v72, s45
    v_perm_b32 v57, v77, v73, s44
    v_perm_b32 v77, v77, v73, s45
    v_perm_b32 v58, v78, v74, s44
    v_perm_b32 v78, v78, v74, s45
    v_perm_b32 v59, v79, v75, s44
    v_perm_b32 v79, v79, v75, s45
    v_dot2_f32_bf16 v32, v56, v115, v32
    v_dot2_f32_bf16 v33, v76, v115, v33
    v_dot2_f32_bf16 v34, v57, v115, v34
    v_dot2_f32_bf16 v35, v77, v115, v35
    v_dot2_f32_bf16 v36, v58, v115, v36
    v_dot2_f32_bf16 v37, v78, v115, v37
    v_dot2_f32_bf16 v38, v59, v115, v38
    v_dot2_f32_bf16 v39, v79, v115, v39
    v_dot2_f32_bf16 v40, v56, v121, v40
    v_dot2_f32_bf16 v41, v76, v121, v41
    v_dot2_f32_bf16 v42, v57, v121, v42
    v_dot2_f32_bf16 v43, v77, v121, v43
    v_dot2_f32_bf16 v44, v58, v121, v44
    v_dot2_f32_bf16 v45, v78, v121, v45
    v_dot2_f32_bf16 v46, v59, v121, v46
    v_dot2_f32_bf16 v47, v79, v121, v47
    s_waitcnt vmcnt(4)
    v_perm_b32 v56, v84, v80, s44
    v_perm_b32 v84, v84, v80, s45
    v_perm_b32 v57, v85, v81, s44
    v_perm_b32 v85, v85, v81, s45
    v_perm_b32 v58, v86, v82, s44
    v_perm_b32 v86, v86, v82, s45
    v_perm_b32 v59, v87, v83, s44
    v_perm_b32 v87, v87, v83, s45
    v_dot2_f32_bf16 v32, v56, v116, v32
    v_dot2_f32_bf16 v33, v84, v116, v33
    v_dot2_f32_bf16 v34, v57, v116, v34
    v_dot2_f32_bf16 v35, v85, v116, v35
    v_dot2_f32_bf16 v36, v58, v116, v36
    v_dot2_f32_bf16 v37, v86, v116, v37
    v_dot2_f32_bf16 v38, v59, v116, v38
    v_dot2_f32_bf16 v39, v87, v116, v39
    v_dot2_f32_bf16 v40, v56, v122, v40
    v_dot2_f32_bf16 v41, v84, v122, v41
    v_dot2_f32_bf16 v42, v57, v122, v42
    v_dot2_f32_bf16 v43, v85, v122, v43
    v_dot2_f32_bf16 v44, v58, v122, v44
    v_dot2_f32_bf16 v45, v86, v122, v45
    v_dot2_f32_bf16 v46, v59, v122, v46
    v_dot2_f32_bf16 v47, v87, v122, v47
    s_waitcnt vmcnt(2)
    v_perm_b32 v56, v92, v88, s44
    v_perm_b32 v92, v92, v88, s45
    v_perm_b32 v57, v93, v89, s44
    v_perm_b32 v93, v93, v89, s45
    v_perm_b32 v58, v94, v90, s44
    v_perm_b32 v94, v94, v90, s45
    v_perm_b32 v59, v95, v91, s44
    v_perm_b32 v95, v95, v91, s45
    v_dot2_f32_bf16 v32, v56, v117, v32
    v_dot2_f32_bf16 v33, v92, v117, v33
    v_dot2_f32_bf16 v34, v57, v117, v34
    v_dot2_f32_bf16 v35, v93, v117, v35
    v_dot2_f32_bf16 v36, v58, v117, v36
    v_dot2_f32_bf16 v37, v94, v117, v37
    v_dot2_f32_bf16 v38, v59, v117, v38
    v_dot2_f32_bf16 v39, v95, v117, v39
    v_dot2_f32_bf16 v40, v56, v123, v40
    v_dot2_f32_bf16 v41, v92, v123, v41
    v_dot2_f32_bf16 v42, v57, v123, v42
    v_dot2_f32_bf16 v43, v93, v123, v43
    v_dot2_f32_bf16 v44, v58, v123, v44
    v_dot2_f32_bf16 v45, v94, v123, v45
    v_dot2_f32_bf16 v46, v59, v123, v46
    v_dot2_f32_bf16 v47, v95, v123, v47
    s_waitcnt vmcnt(0)
    v_perm_b32 v56, v100, v96, s44
    v_perm_b32 v100, v100, v96, s45
    v_perm_b32 v57, v101, v97, s44
    v_perm_b32 v101, v101, v97, s45
    v_perm_b32 v58, v102, v98, s44
    v_perm_b32 v102, v102, v98, s45
    v_perm_b32 v59, v103, v99, s44
    v_perm_b32 v103, v103, v99, s45
    v_dot2_f32_bf16 v32, v56, v118, v32
    v_dot2_f32_bf16 v33, v100, v118, v33
    v_dot2_f32_bf16 v34, v57, v118, v34
    v_dot2_f32_bf16 v35, v101, v118, v35
    v_dot2_f32_bf16 v36, v58, v118, v36
    v_dot2_f32_bf16 v37, v102, v118, v37
    v_dot2_f32_bf16 v38, v59, v118, v38
    v_dot2_f32_bf16 v39, v103, v118, v39
    v_dot2_f32_bf16 v40, v56, v124, v40
    v_dot2_f32_bf16 v41, v100, v124, v41
    v_dot2_f32_bf16 v42, v57, v124, v42
    v_dot2_f32_bf16 v43, v101, v124, v43
    v_dot2_f32_bf16 v44, v58, v124, v44
    v_dot2_f32_bf16 v45, v102, v124, v45
    v_dot2_f32_bf16 v46, v59, v124, v46
    v_dot2_f32_bf16 v47, v103, v124, v47
    v_permlane32_swap_b32 v32, v40
    v_permlane32_swap_b32 v33, v41
    v_permlane32_swap_b32 v34, v42
    v_permlane32_swap_b32 v35, v43
    v_permlane32_swap_b32 v36, v44
    v_permlane32_swap_b32 v37, v45
    v_permlane32_swap_b32 v38, v46
    v_permlane32_swap_b32 v39, v47
    v_add_f32 v32, v32, v40
    v_add_f32 v33, v33, v41
    v_add_f32 v34, v34, v42
    v_add_f32 v35, v35, v43
    v_add_f32 v36, v36, v44
    v_add_f32 v37, v37, v45
    v_add_f32 v38, v38, v46
    v_add_f32 v39, v39, v47
    v_permlane16_swap_b32 v32, v36
    v_permlane16_swap_b32 v33, v37
    v_permlane16_swap_b32 v34, v38
    v_permlane16_swap_b32 v35, v39
    v_add_f32 v32, v32, v36
    v_add_f32 v33, v33, v37
    v_add_f32 v34, v34, v38
    v_add_f32 v35, v35, v39
    v_add_f32_dpp v32, v32, v32 row_ror:8 row_mask:0xf bank_mask:0xf
    v_add_f32_dpp v33, v33, v33 row_ror:8 row_mask:0xf bank_mask:0xf
    v_add_f32_dpp v34, v34, v34 row_ror:8 row_mask:0xf bank_mask:0xf
    v_add_f32_dpp v35, v35, v35 row_ror:8 row_mask:0xf bank_mask:0xf
    v_add_u32 v32, 0x80, v32
    v_add_u32 v33, 0x80, v33
    v_add_u32 v34, 0x80, v34
    v_add_u32 v35, 0x80, v35
    v_and_or_b32 v36, v32, s42, v50
    v_and_or_b32 v37, v33, s42, v50
    v_and_or_b32 v38, v34, s42, v50
    v_and_or_b32 v39, v35, s42, v50
    v_mov_b32 v51, v48
    s_mov_b32 exec_lo, 0x00ff00ff
    s_mov_b32 exec_hi, 0x00ff00ff
    buffer_store_dwordx4 v[36:39], v51, s[36:39], s59 offen sc1
    s_mov_b64 exec, -1
    s_cmp_eq_u32 s30, 0
    s_cbranch_scc1 L_nowda
    buffer_load_dwordx2 v[22:23], v31, s[28:31], s65 offen offset:0 nt
    buffer_load_dwordx2 v[24:25], v31, s[28:31], s65 offen offset:1280 nt
    buffer_load_dwordx2 v[26:27], v31, s[28:31], s65 offen offset:2560 nt
    buffer_load_dwordx2 v[28:29], v31, s[28:31], s65 offen offset:3840 nt
L_nowda:
    s_mul_i32 s64, s40, 163840
    s_lshl_b32 s59, s3, 7
    s_add_u32 s64, s64, s59
    s_add_u32 s59, s64, 81664
    s_cmp_ge_u32 s3, 10
    s_cselect_b32 s64, s59, s64
    v_mul_u32_u24 v30, 2560, v2
    v_lshl_add_u32 v30, v3, 3, v30
    s_add_u32 s61, s64, 0
    buffer_load_dwordx2 v[32:33], v30, s[24:27], s61 offen offset:0
    s_xor_b32 s50, s49, 0
    buffer_load_dwordx4 v[64:67], v4, s[12:15], s50 offen nt
    buffer_load_dwordx2 v[34:35], v30, s[24:27], s61 offen offset:1280
    s_xor_b32 s50, s49, 1024
    buffer_load_dwordx4 v[68:71], v4, s[12:15], s50 offen nt
    s_add_u32 s61, s64, 10240
    buffer_load_dwordx2 v[36:37], v30, s[24:27], s61 offen offset:0
    s_xor_b32 s50, s49, 2048
    buffer_load_dwordx4 v[72:75], v4, s[12:15], s50 offen nt
    buffer_load_dwordx2 v[38:39], v30, s[24:27], s61 offen offset:1280
    s_xor_b32 s50, s49, 3072
    buffer_load_dwordx4 v[76:79], v4, s[12:15], s50 offen nt
    s_add_u32 s61, s64, 20480
    buffer_load_dwordx2 v[40:41], v30, s[24:27], s61 offen offset:0
    s_xor_b32 s50, s49, 65536
    buffer_load_dwordx4 v[80:83], v4, s[12:15], s50 offen nt
    buffer_load_dwordx2 v[42:43], v30, s[24:27], s61 offen offset:1280
    s_xor_b32 s50, s49, 66560
    buffer_load_dwordx4 v[84:87], v4, s[12:15], s50 offen nt
    s_add_u32 s61, s64, 30720
    buffer_load_dwordx2 v[44:45], v30, s[24:27], s61 offen offset:0
    s_xor_b32 s50, s49, 67584
    buffer_load_dwordx4 v[88:91], v4, s[12:15], s50 offen nt
    buffer_load_dwordx2 v[46:47], v30, s[24:27], s61 offen offset:1280
    s_xor_b32 s50, s49, 68608
    buffer_load_dwordx4 v[92:95], v4, s[12:15], s50 offen nt
    s_add_u32 s61, s64, 40960
    buffer_load_dwordx2 v[48:49], v30, s[24:27], s61 offen offset:0
    s_xor_b32 s50, s49, 131072
    buffer_load_dwordx4 v[96:99], v4, s[12:15], s50 offen nt
    buffer_load_dwordx2 v[50:51], v30, s[24:27], s61 offen offset:1280
    s_xor_b32 s50, s49, 132096
    buffer_load_dwordx4 v[100:103], v4, s[12:15], s50 offen nt
    s_add_u32 s61, s64, 51200
    buffer_load_dwordx2 v[52:53], v30, s[24:27], s61 offen offset:0
    s_xor_b32 s50, s49, 133120
    buffer_load_dwordx4 v[104:107], v4, s[12:15], s50 offen nt
    buffer_load_dwordx2 v[54:55], v30, s[24:27], s61 offen offset:1280
    s_xor_b32 s50, s49, 134144
    buffer_load_dwordx4 v[108:111], v4, s[12:15], s50 offen nt
    s_add_u32 s61, s64, 61440
    buffer_load_dwordx2 v[56:57], v30, s[24:27], s61 offen offset:0
    s_xor_b32 s50, s49, 196608
    buffer_load_dwordx4 v[112:115], v4, s[12:15], s50 offen nt
    buffer_load_dwordx2 v[58:59], v30, s[24:27], s61 offen offset:1280
    s_xor_b32 s50, s49, 197632
    buffer_load_dwordx4 v[116:119], v4, s[12:15], s50 offen nt
    s_add_u32 s61, s64, 71680
    buffer_load_dwordx2 v[60:61], v30, s[24:27], s61 offen offset:0
    s_xor_b32 s50, s49, 198656
    buffer_load_dwordx4 v[120:123], v4, s[12:15], s50 offen nt
    buffer_load_dwordx2 v[62:63], v30, s[24:27], s61 offen offset:1280
    s_xor_b32 s50, s49, 199680
    buffer_load_dwordx4 v[124:127], v4, s[12:15], s50 offen nt
    s_lshl_b32 s59, s54, 10
    s_add_u32 s59, s59, s70
    s_cmp_lt_u32 s3, 2
    s_cbranch_scc1 L_qgs
    s_cmp_eq_u32 s3, 2
    s_cbranch_scc1 L_hid
    s_branch L_adone
L_qgs:
    s_add_u32 s59, s59, s60
    s_add_u32 s58, s59, 8192
    v_lshlrev_b32 v6, 11, v2
    v_lshl_add_u32 v6, v3, 4, v6
    buffer_load_dwordx4 v[10:13], v6, s[36:39], s59 offen
    buffer_load_dwordx4 v[14:17], v6, s[36:39], s58 offen
    s_waitcnt vmcnt(0)
    s_branch L_qg1
L_qg:
    buffer_load_dwordx4 v[10:13], v6, s[36:39], s59 offen sc1
    buffer_load_dwordx4 v[14:17], v6, s[36:39], s58 offen sc1
    s_waitcnt vmcnt(0)
L_qg1:
    v_xor_b32 v10, s43, v10
    v_xor_b32 v11, s43, v11
    v_xor_b32 v12, s43, v12
    v_xor_b32 v13, s43, v13
    v_xor_b32 v14, s43, v14
    v_xor_b32 v15, s43, v15
    v_xor_b32 v16, s43, v16
    v_xor_b32 v17, s43, v17
    v_or3_b32 v7, v10, v11, v12
    v_or3_b32 v7, v7, v13, v14
    v_or3_b32 v7, v7, v15, v16
    v_or_b32 v7, v7, v17
    v_lshlrev_b32 v7, 24, v7
    v_cmp_ne_u32 vcc, 0, v7
    s_nop 0
    s_cmp_eq_u64 vcc, 0
    s_cbranch_scc1 L_qgok
    s_sub_u32 s71, s71, 1
    s_cbranch_scc0 L_qg
    s_endpgm
L_qgok:
    v_add_f32 v10, v10, v14
    v_add_f32 v11, v11, v15
    v_add_f32 v12, v12, v16
    v_add_f32 v13, v13, v17
    s_nop 0
    v_permlane32_swap_b32 v10, v12
    v_permlane32_swap_b32 v11, v13
    v_add_f32 v10, v10, v12
    v_add_f32 v11, v11, v13
    v_mov_b32 v12, v10
    v_mov_b32 v13, v11
    s_nop 0
    v_permlane16_swap_b32 v10, v12
    v_permlane16_swap_b32 v11, v13
    v_add_f32 v10, v10, v12
    v_add_f32 v11, v11, v13
    v_cvt_pk_bf16_f32 v10, v10, v11
    s_lshl_b32 s59, s3, 7
    v_lshrrev_b32 v7, 5, v1
    v_lshl_add_u32 v7, v7, 2, s59
    v_lshl_add_u32 v7, v3, 3, v7
    ds_write_b32 v7, v10 offset:10368
    v_mov_b32 v6, 0
    v_mov_b32 v8, 1
    v_mov_b32 v9, s69
    s_mov_b64 exec, 1
    ds_write_b32 v6, v9 offset:10816
    ds_add_u32 v6, v8 offset:10720
    s_mov_b64 exec, -1
    s_branch L_adone
L_hid:
    s_lshl_b32 s60, s67, 6
    s_add_u32 s59, s59, s60
    v_lshrrev_b32 v6, 3, v1
    v_lshlrev_b32 v6, 11, v6
    v_and_b32 v7, 4, v1
    v_lshl_add_u32 v6, v7, 6, v6
    v_and_b32 v8, 3, v1
    v_lshl_add_u32 v6, v8, 4, v6
    buffer_load_dwordx4 v[10:13], v6, s[36:39], s59 offen offset:512
    s_waitcnt vmcnt(0)
    s_branch L_hg1
L_hg:
    buffer_load_dwordx4 v[10:13], v6, s[36:39], s59 offen offset:512 sc1
    s_waitcnt vmcnt(0)
L_hg1:
    v_xor_b32 v10, s43, v10
    v_xor_b32 v11, s43, v11
    v_xor_b32 v12, s43, v12
    v_xor_b32 v13, s43, v13
    v_or3_b32 v7, v10, v11, v12
    v_or_b32 v7, v7, v13
    v_lshlrev_b32 v7, 24, v7
    v_cmp_ne_u32 vcc, 0, v7
    s_nop 0
    s_cmp_eq_u64 vcc, 0
    s_cbranch_scc1 L_hgok
    s_sub_u32 s71, s71, 1
    s_cbranch_scc0 L_hg
    s_endpgm
L_hgok:
    v_add_f32_dpp v10, v10, v10 row_ror:8 row_mask:0xf bank_mask:0xf
    v_add_f32_dpp v11, v11, v11 row_ror:8 row_mask:0xf bank_mask:0xf
    v_add_f32_dpp v12, v12, v12 row_ror:8 row_mask:0xf bank_mask:0xf
    v_add_f32_dpp v13, v13, v13 row_ror:8 row_mask:0xf bank_mask:0xf
    v_mov_b32 v14, v10
    v_mov_b32 v15, v11
    v_mov_b32 v16, v12
    v_mov_b32 v17, v13
    v_permlane16_swap_b32 v10, v14
    v_permlane16_swap_b32 v11, v15
    v_permlane16_swap_b32 v12, v16
    v_permlane16_swap_b32 v13, v17
    v_add_f32 v10, v10, v14
    v_add_f32 v11, v11, v15
    v_add_f32 v12, v12, v16
    v_add_f32 v13, v13, v17
    v_mov_b32 v14, v10
    v_mov_b32 v15, v11
    v_mov_b32 v16, v12
    v_mov_b32 v17, v13
    v_permlane32_swap_b32 v10, v14
    v_permlane32_swap_b32 v11, v15
    v_permlane32_swap_b32 v12, v16
    v_permlane32_swap_b32 v13, v17
    v_add_f32 v10, v10, v14
    v_add_f32 v11, v11, v15
    v_add_f32 v12, v12, v16
    v_add_f32 v13, v13, v17
    v_cvt_pk_bf16_f32 v10, v10, v10
    v_cvt_pk_bf16_f32 v11, v11, v11
    v_cvt_pk_bf16_f32 v12, v12, v12
    v_cvt_pk_bf16_f32 v13, v13, v13
    v_lshlrev_b32 v10, 16, v10
    v_lshlrev_b32 v11, 16, v11
    v_lshlrev_b32 v12, 16, v12
    v_lshlrev_b32 v13, 16, v13
    v_mul_f32 v18, v10, v10
    v_mul_f32 v19, v11, v11
    v_mul_f32 v20, v12, v12
    v_mul_f32 v21, v13, v13
    v_mov_b32 v14, 0xc0135761
    v_mov_b32 v15, 0xc0135761
    v_mov_b32 v16, 0xc0135761
    v_mov_b32 v17, 0xc0135761
    v_fmac_f32 v14, 0xbdd2d3e8, v18
    v_fmac_f32 v15, 0xbdd2d3e8, v19
    v_fmac_f32 v16, 0xbdd2d3e8, v20
    v_fmac_f32 v17, 0xbdd2d3e8, v21
    v_mul_f32 v14, v14, v10
    v_mul_f32 v15, v15, v11
    v_mul_f32 v16, v16, v12
    v_mul_f32 v17, v17, v13
    v_exp_f32 v14, v14
    v_exp_f32 v15, v15
    v_exp_f32 v16, v16
    v_exp_f32 v17, v17
    v_add_f32 v14, 1.0, v14
    v_add_f32 v15, 1.0, v15
    v_add_f32 v16, 1.0, v16
    v_add_f32 v17, 1.0, v17
    v_rcp_f32 v14, v14
    v_rcp_f32 v15, v15
    v_rcp_f32 v16, v16
    v_rcp_f32 v17, v17
    v_mul_f32 v14, v14, v10
    v_mul_f32 v15, v15, v11
    v_mul_f32 v16, v16, v12
    v_mul_f32 v17, v17, v13
    v_cvt_pk_bf16_f32 v14, v14, v14
    v_cvt_pk_bf16_f32 v15, v15, v15
    v_cvt_pk_bf16_f32 v16, v16, v16
    v_cvt_pk_bf16_f32 v17, v17, v17
    v_lshlrev_b32 v14, 16, v14
    v_lshlrev_b32 v15, 16, v15
    v_lshlrev_b32 v16, 16, v16
    v_lshlrev_b32 v17, 16, v17
    v_mul_f32_dpp v14, v10, v14 row_ror:12 row_mask:0xf bank_mask:0xf
    v_mul_f32_dpp v15, v11, v15 row_ror:12 row_mask:0xf bank_mask:0xf
    v_mul_f32_dpp v16, v12, v16 row_ror:12 row_mask:0xf bank_mask:0xf
    v_mul_f32_dpp v17, v13, v17 row_ror:12 row_mask:0xf bank_mask:0xf
    v_cvt_pk_bf16_f32 v10, v14, v15
    v_cvt_pk_bf16_f32 v11, v16, v17
    v_lshlrev_b32 v7, 3, v8
    v_mov_b32 v8, 1
    s_mov_b64 exec, 0xf
    ds_write_b64 v7, v[10:11] offset:10624
    s_mov_b64 exec, 1
    ds_write_b32 v7, v8 offset:10724
    s_mov_b64 exec, -1
L_adone:
    s_setprio 1
    s_branch L_kdone
L_bentry:
    s_lshl_b32 s49, s41, 20
    s_lshl_b32 s5, s67, 14
    s_or_b32 s49, s49, s5
    v_and_b32 v4, 63, v0
    v_lshlrev_b32 v4, 4, v4
    v_and_b32 v6, 0xc0, v0
    v_lshl_or_b32 v4, v6, 6, v4
    v_and_b32 v6, 0x300, v0
    v_lshl_or_b32 v4, v6, 10, v4
    s_mov_b32 s14, 67108864
    s_mov_b32 s15, 0x20000
    s_mov_b32 s71, 0x40000
    s_mov_b32 s44, 0x05040100
    s_mov_b32 s45, 0x07060302
    s_movk_i32 s42, 0xff00
    s_waitcnt lgkmcnt(0)
    s_mov_b64 s[12:13], s[74:75]
    s_and_b32 s66, s55, 31
    v_and_b32 v1, 63, v0
    s_mov_b64 s[8:9], s[72:73]
    s_movk_i32 s10, 2560
    s_mov_b32 s11, 0x20000
    s_mov_b32 s46, 0xffff0000
    v_lshrrev_b32 v2, 4, v1
    v_and_b32 v3, 15, v1
    s_lshr_b32 s54, s55, 5
    s_mov_b64 s[36:37], s[94:95]
    s_mov_b32 s38, 268435456
    s_mov_b32 s39, 0x20000
    s_mov_b64 s[28:29], s[88:89]
    s_mov_b32 s31, 0x20000
    s_mov_b64 s[16:17], s[76:77]
    s_mov_b32 s18, 67108864
    s_mov_b32 s19, 0x20000
    s_mov_b64 s[24:25], s[80:81]
    s_mov_b32 s26, 5242880
    s_mov_b32 s27, 0x20000
    s_mov_b64 s[32:33], s[90:91]
    s_mov_b32 s34, 2560
    s_mov_b32 s35, 0x20000
    s_lshl2_add_u32 s58, s66, s67
    s_sub_u32 s56, s58, 108
    s_cselect_b32 s56, -1, s56
    s_cselect_b32 s60, 2211840, 0
    s_lshl2_add_u32 s59, s96, s67
    s_mul_i32 s65, s59, 20480
    s_lshl_b32 s59, s3, 7
    s_add_u32 s65, s65, s59
    s_cmp_lt_u32 s3, 10
    s_cselect_b32 s30, s60, 0
    v_mul_u32_u24 v31, 5120, v2
    v_lshl_add_u32 v31, v3, 3, v31
    s_setprio 2
    s_barrier
    s_cmp_eq_u32 s30, 0
    s_cbranch_scc1 L_nowdb
    buffer_load_dwordx2 v[22:23], v31, s[28:31], s65 offen offset:0 nt
    buffer_load_dwordx2 v[24:25], v31, s[28:31], s65 offen offset:1280 nt
    buffer_load_dwordx2 v[26:27], v31, s[28:31], s65 offen offset:2560 nt
    buffer_load_dwordx2 v[28:29], v31, s[28:31], s65 offen offset:3840 nt
L_nowdb:
    s_cmp_lg_u32 s3, 12
    s_cbranch_scc1 L_nopfa
    s_bfe_u32 s58, s2, 0x30003
    s_lshl3_add_u32 s58, s40, s58
    s_mul_i32 s58, s58, 20480
    s_add_u32 s59, s58, 8192
    s_add_u32 s60, s58, 16384
    v_lshlrev_b32 v6, 7, v1
    buffer_load_dword v60, v6, s[24:27], s58 offen
    buffer_load_dword v61, v6, s[24:27], s59 offen
    s_mov_b32 exec_hi, 0
    buffer_load_dword v62, v6, s[24:27], s60 offen
    s_mov_b64 exec, -1
L_nopfa:
    s_setprio 1
    s_cmp_ge_u32 s3, 12
    s_cbranch_scc1 L_kplain
    s_mul_i32 s64, s40, 163840
    s_lshl_b32 s59, s3, 7
    s_add_u32 s64, s64, s59
    s_add_u32 s59, s64, 81664
    s_cmp_ge_u32 s3, 10
    s_cselect_b32 s64, s59, s64
    v_mul_u32_u24 v30, 2560, v2
    v_lshl_add_u32 v30, v3, 3, v30
    s_add_u32 s61, s64, 0
    buffer_load_dwordx2 v[32:33], v30, s[24:27], s61 offen offset:0
    s_xor_b32 s50, s49, 0
    buffer_load_dwordx4 v[64:67], v4, s[12:15], s50 offen nt
    buffer_load_dwordx2 v[34:35], v30, s[24:27], s61 offen offset:1280
    s_xor_b32 s50, s49, 1024
    buffer_load_dwordx4 v[68:71], v4, s[12:15], s50 offen nt
    s_add_u32 s61, s64, 10240
    buffer_load_dwordx2 v[36:37], v30, s[24:27], s61 offen offset:0
    s_xor_b32 s50, s49, 2048
    buffer_load_dwordx4 v[72:75], v4, s[12:15], s50 offen nt
    buffer_load_dwordx2 v[38:39], v30, s[24:27], s61 offen offset:1280
    s_xor_b32 s50, s49, 3072
    buffer_load_dwordx4 v[76:79], v4, s[12:15], s50 offen nt
    s_add_u32 s61, s64, 20480
    buffer_load_dwordx2 v[40:41], v30, s[24:27], s61 offen offset:0
    s_xor_b32 s50, s49, 65536
    buffer_load_dwordx4 v[80:83], v4, s[12:15], s50 offen nt
    buffer_load_dwordx2 v[42:43], v30, s[24:27], s61 offen offset:1280
    s_xor_b32 s50, s49, 66560
    buffer_load_dwordx4 v[84:87], v4, s[12:15], s50 offen nt
    s_add_u32 s61, s64, 30720
    buffer_load_dwordx2 v[44:45], v30, s[24:27], s61 offen offset:0
    s_xor_b32 s50, s49, 67584
    buffer_load_dwordx4 v[88:91], v4, s[12:15], s50 offen nt
    buffer_load_dwordx2 v[46:47], v30, s[24:27], s61 offen offset:1280
    s_xor_b32 s50, s49, 68608
    buffer_load_dwordx4 v[92:95], v4, s[12:15], s50 offen nt
    s_add_u32 s61, s64, 40960
    buffer_load_dwordx2 v[48:49], v30, s[24:27], s61 offen offset:0
    s_xor_b32 s50, s49, 131072
    buffer_load_dwordx4 v[96:99], v4, s[12:15], s50 offen nt
    buffer_load_dwordx2 v[50:51], v30, s[24:27], s61 offen offset:1280
    s_xor_b32 s50, s49, 132096
    buffer_load_dwordx4 v[100:103], v4, s[12:15], s50 offen nt
    s_add_u32 s61, s64, 51200
    buffer_load_dwordx2 v[52:53], v30, s[24:27], s61 offen offset:0
    s_xor_b32 s50, s49, 133120
    buffer_load_dwordx4 v[104:107], v4, s[12:15], s50 offen nt
    buffer_load_dwordx2 v[54:55], v30, s[24:27], s61 offen offset:1280
    s_xor_b32 s50, s49, 134144
    buffer_load_dwordx4 v[108:111], v4, s[12:15], s50 offen nt
    s_add_u32 s61, s64, 61440
    buffer_load_dwordx2 v[56:57], v30, s[24:27], s61 offen offset:0
    s_xor_b32 s50, s49, 196608
    buffer_load_dwordx4 v[112:115], v4, s[12:15], s50 offen nt
    buffer_load_dwordx2 v[58:59], v30, s[24:27], s61 offen offset:1280
    s_xor_b32 s50, s49, 197632
    buffer_load_dwordx4 v[116:119], v4, s[12:15], s50 offen nt
    s_add_u32 s61, s64, 71680
    buffer_load_dwordx2 v[60:61], v30, s[24:27], s61 offen offset:0
    s_xor_b32 s50, s49, 198656
    buffer_load_dwordx4 v[120:123], v4, s[12:15], s50 offen nt
    buffer_load_dwordx2 v[62:63], v30, s[24:27], s61 offen offset:1280
    s_xor_b32 s50, s49, 199680
    buffer_load_dwordx4 v[124:127], v4, s[12:15], s50 offen nt
    s_branch L_kdone
L_kplain:
    s_setprio 2
    s_xor_b32 s50, s49, 0
    buffer_load_dwordx4 v[64:67], v4, s[12:15], s50 offen nt
    s_xor_b32 s50, s49, 1024
    buffer_load_dwordx4 v[68:71], v4, s[12:15], s50 offen nt
    s_xor_b32 s50, s49, 2048
    buffer_load_dwordx4 v[72:75], v4, s[12:15], s50 offen nt
    s_xor_b32 s50, s49, 3072
    buffer_load_dwordx4 v[76:79], v4, s[12:15], s50 offen nt
    s_xor_b32 s50, s49, 65536
    buffer_load_dwordx4 v[80:83], v4, s[12:15], s50 offen nt
    s_xor_b32 s50, s49, 66560
    buffer_load_dwordx4 v[84:87], v4, s[12:15], s50 offen nt
    s_xor_b32 s50, s49, 67584
    buffer_load_dwordx4 v[88:91], v4, s[12:15], s50 offen nt
    s_xor_b32 s50, s49, 68608
    buffer_load_dwordx4 v[92:95], v4, s[12:15], s50 offen nt
    s_xor_b32 s50, s49, 131072
    buffer_load_dwordx4 v[96:99], v4, s[12:15], s50 offen nt
    s_xor_b32 s50, s49, 132096
    buffer_load_dwordx4 v[100:103], v4, s[12:15], s50 offen nt
    s_xor_b32 s50, s49, 133120
    buffer_load_dwordx4 v[104:107], v4, s[12:15], s50 offen nt
    s_xor_b32 s50, s49, 134144
    buffer_load_dwordx4 v[108:111], v4, s[12:15], s50 offen nt
    s_xor_b32 s50, s49, 196608
    buffer_load_dwordx4 v[112:115], v4, s[12:15], s50 offen nt
    s_xor_b32 s50, s49, 197632
    buffer_load_dwordx4 v[116:119], v4, s[12:15], s50 offen nt
    s_xor_b32 s50, s49, 198656
    buffer_load_dwordx4 v[120:123], v4, s[12:15], s50 offen nt
    s_xor_b32 s50, s49, 199680
    buffer_load_dwordx4 v[124:127], v4, s[12:15], s50 offen nt
    s_setprio 1
L_kdone:
    s_mul_i32 s64, s40, 163840
    s_lshl_b32 s59, s3, 7
    s_add_u32 s64, s64, s59
    s_add_u32 s59, s64, 81664
    s_cmp_ge_u32 s3, 10
    s_cselect_b32 s64, s59, s64
    s_mul_i32 s53, s54, 10
    s_lshl1_add_u32 s60, s54, 12
    s_cmp_ge_u32 s3, 10
    s_cselect_b32 s53, s60, s53
    s_lshl2_add_u32 s58, s66, s67
    s_add_u32 s53, s53, s3
    s_lshl_b32 s53, s53, 15
    s_lshl_b32 s58, s58, 7
    s_add_u32 s53, s53, s58
    s_lshl_b32 s57, s55, 7
    s_add_u32 s57, s57, 1048576
    v_lshrrev_b32 v5, 3, v3
    v_lshlrev_b32 v5, 14, v5
    v_and_b32 v30, 7, v1
    v_lshl_add_u32 v5, v30, 4, v5
    s_lshl_b32 s59, s3, 9
    v_lshlrev_b32 v0, 5, v3
    v_lshl_add_u32 v0, v2, 3, v0
    v_add_u32 v0, s59, v0
    s_mov_b32 s47, 0x3db504f3
    s_mov_b32 s48, 0x3fb8aa3b
    v_mov_b32 v11, 0
    v_lshlrev_b32 v12, 4, v3
L_qw:
    ds_read_b32 v13, v11 offset:10720
    ds_read_b128 v[6:9], v12 offset:10368
    ds_read_b32 v14, v11 offset:10816
    s_waitcnt lgkmcnt(0)
    v_readfirstlane_b32 s59, v13
    s_nop 0
    s_cmp_eq_u32 s59, 2
    s_cbranch_scc1 L_qwok
    s_sleep 2
    s_sub_u32 s71, s71, 1
    s_cbranch_scc0 L_qw
    s_endpgm
L_qwok:
    v_readfirstlane_b32 s69, v14
    s_waitcnt vmcnt(12)
    v_dot2_f32_bf16 v64, v64, v6, 0
    v_dot2_f32_bf16 v68, v68, v6, 0
    v_dot2_f32_bf16 v72, v72, v6, 0
    v_dot2_f32_bf16 v76, v76, v6, 0
    v_dot2_f32_bf16 v64, v65, v7, v64
    v_dot2_f32_bf16 v68, v69, v7, v68
    v_dot2_f32_bf16 v72, v73, v7, v72
    v_dot2_f32_bf16 v76, v77, v7, v76
    v_dot2_f32_bf16 v64, v66, v8, v64
    v_dot2_f32_bf16 v68, v70, v8, v68
    v_dot2_f32_bf16 v72, v74, v8, v72
    v_dot2_f32_bf16 v76, v78, v8, v76
    v_dot2_f32_bf16 v64, v67, v9, v64
    v_dot2_f32_bf16 v68, v71, v9, v68
    v_dot2_f32_bf16 v72, v75, v9, v72
    v_dot2_f32_bf16 v76, v79, v9, v76
    v_add_f32_dpp v64, v64, v64 row_ror:8 row_mask:0xf bank_mask:0xf
    v_add_f32_dpp v68, v68, v68 row_ror:8 row_mask:0xf bank_mask:0xf
    v_add_f32_dpp v72, v72, v72 row_ror:8 row_mask:0xf bank_mask:0xf
    v_add_f32_dpp v76, v76, v76 row_ror:8 row_mask:0xf bank_mask:0xf
    v_add_f32_dpp v64, v64, v64 row_ror:4 row_mask:0xf bank_mask:0xf
    v_add_f32_dpp v68, v68, v68 row_ror:4 row_mask:0xf bank_mask:0xf
    v_add_f32_dpp v72, v72, v72 row_ror:4 row_mask:0xf bank_mask:0xf
    v_add_f32_dpp v76, v76, v76 row_ror:4 row_mask:0xf bank_mask:0xf
    v_add_f32_dpp v64, v64, v64 row_ror:2 row_mask:0xf bank_mask:0xf
    v_add_f32_dpp v68, v68, v68 row_ror:2 row_mask:0xf bank_mask:0xf
    v_add_f32_dpp v72, v72, v72 row_ror:2 row_mask:0xf bank_mask:0xf
    v_add_f32_dpp v76, v76, v76 row_ror:2 row_mask:0xf bank_mask:0xf
    v_add_f32_dpp v64, v64, v64 row_ror:1 row_mask:0xf bank_mask:0xf
    v_add_f32_dpp v68, v68, v68 row_ror:1 row_mask:0xf bank_mask:0xf
    v_add_f32_dpp v72, v72, v72 row_ror:1 row_mask:0xf bank_mask:0xf
    v_add_f32_dpp v76, v76, v76 row_ror:1 row_mask:0xf bank_mask:0xf
    v_cvt_pk_bf16_f32 v68, v64, v68
    v_cvt_pk_bf16_f32 v76, v72, v76
    v_lshlrev_b32 v64, 16, v68
    v_and_b32 v68, s46, v68
    v_lshlrev_b32 v72, 16, v76
    v_and_b32 v76, s46, v76
    v_mul_f32 v64, s47, v64
    v_mul_f32 v68, s47, v68
    v_mul_f32 v72, s47, v72
    v_mul_f32 v76, s47, v76
    v_cvt_pk_bf16_f32 v68, v64, v68
    v_cvt_pk_bf16_f32 v76, v72, v76
    v_lshlrev_b32 v64, 16, v68
    v_and_b32 v68, s46, v68
    v_lshlrev_b32 v72, 16, v76
    v_and_b32 v76, s46, v76
    s_waitcnt vmcnt(8)
    v_dot2_f32_bf16 v80, v80, v6, 0
    v_dot2_f32_bf16 v84, v84, v6, 0
    v_dot2_f32_bf16 v88, v88, v6, 0
    v_dot2_f32_bf16 v92, v92, v6, 0
    v_dot2_f32_bf16 v80, v81, v7, v80
    v_dot2_f32_bf16 v84, v85, v7, v84
    v_dot2_f32_bf16 v88, v89, v7, v88
    v_dot2_f32_bf16 v92, v93, v7, v92
    v_dot2_f32_bf16 v80, v82, v8, v80
    v_dot2_f32_bf16 v84, v86, v8, v84
    v_dot2_f32_bf16 v88, v90, v8, v88
    v_dot2_f32_bf16 v92, v94, v8, v92
    v_dot2_f32_bf16 v80, v83, v9, v80
    v_dot2_f32_bf16 v84, v87, v9, v84
    v_dot2_f32_bf16 v88, v91, v9, v88
    v_dot2_f32_bf16 v92, v95, v9, v92
    v_add_f32_dpp v80, v80, v80 row_ror:8 row_mask:0xf bank_mask:0xf
    v_add_f32_dpp v84, v84, v84 row_ror:8 row_mask:0xf bank_mask:0xf
    v_add_f32_dpp v88, v88, v88 row_ror:8 row_mask:0xf bank_mask:0xf
    v_add_f32_dpp v92, v92, v92 row_ror:8 row_mask:0xf bank_mask:0xf
    v_add_f32_dpp v80, v80, v80 row_ror:4 row_mask:0xf bank_mask:0xf
    v_add_f32_dpp v84, v84, v84 row_ror:4 row_mask:0xf bank_mask:0xf
    v_add_f32_dpp v88, v88, v88 row_ror:4 row_mask:0xf bank_mask:0xf
    v_add_f32_dpp v92, v92, v92 row_ror:4 row_mask:0xf bank_mask:0xf
    v_add_f32_dpp v80, v80, v80 row_ror:2 row_mask:0xf bank_mask:0xf
    v_add_f32_dpp v84, v84, v84 row_ror:2 row_mask:0xf bank_mask:0xf
    v_add_f32_dpp v88, v88, v88 row_ror:2 row_mask:0xf bank_mask:0xf
    v_add_f32_dpp v92, v92, v92 row_ror:2 row_mask:0xf bank_mask:0xf
    v_add_f32_dpp v80, v80, v80 row_ror:1 row_mask:0xf bank_mask:0xf
    v_add_f32_dpp v84, v84, v84 row_ror:1 row_mask:0xf bank_mask:0xf
    v_add_f32_dpp v88, v88, v88 row_ror:1 row_mask:0xf bank_mask:0xf
    v_add_f32_dpp v92, v92, v92 row_ror:1 row_mask:0xf bank_mask:0xf
    v_cvt_pk_bf16_f32 v84, v80, v84
    v_cvt_pk_bf16_f32 v92, v88, v92
    v_lshlrev_b32 v80, 16, v84
    v_and_b32 v84, s46, v84
    v_lshlrev_b32 v88, 16, v92
    v_and_b32 v92, s46, v92
    v_mul_f32 v80, s47, v80
    v_mul_f32 v84, s47, v84
    v_mul_f32 v88, s47, v88
    v_mul_f32 v92, s47, v92
    v_cvt_pk_bf16_f32 v84, v80, v84
    v_cvt_pk_bf16_f32 v92, v88, v92
    v_lshlrev_b32 v80, 16, v84
    v_and_b32 v84, s46, v84
    v_lshlrev_b32 v88, 16, v92
    v_and_b32 v92, s46, v92
    s_waitcnt vmcnt(4)
    v_dot2_f32_bf16 v96, v96, v6, 0
    v_dot2_f32_bf16 v100, v100, v6, 0
    v_dot2_f32_bf16 v104, v104, v6, 0
    v_dot2_f32_bf16 v108, v108, v6, 0
    v_dot2_f32_bf16 v96, v97, v7, v96
    v_dot2_f32_bf16 v100, v101, v7, v100
    v_dot2_f32_bf16 v104, v105, v7, v104
    v_dot2_f32_bf16 v108, v109, v7, v108
    v_dot2_f32_bf16 v96, v98, v8, v96
    v_dot2_f32_bf16 v100, v102, v8, v100
    v_dot2_f32_bf16 v104, v106, v8, v104
    v_dot2_f32_bf16 v108, v110, v8, v108
    v_dot2_f32_bf16 v96, v99, v9, v96
    v_dot2_f32_bf16 v100, v103, v9, v100
    v_dot2_f32_bf16 v104, v107, v9, v104
    v_dot2_f32_bf16 v108, v111, v9, v108
    v_add_f32_dpp v96, v96, v96 row_ror:8 row_mask:0xf bank_mask:0xf
    v_add_f32_dpp v100, v100, v100 row_ror:8 row_mask:0xf bank_mask:0xf
    v_add_f32_dpp v104, v104, v104 row_ror:8 row_mask:0xf bank_mask:0xf
    v_add_f32_dpp v108, v108, v108 row_ror:8 row_mask:0xf bank_mask:0xf
    v_add_f32_dpp v96, v96, v96 row_ror:4 row_mask:0xf bank_mask:0xf
    v_add_f32_dpp v100, v100, v100 row_ror:4 row_mask:0xf bank_mask:0xf
    v_add_f32_dpp v104, v104, v104 row_ror:4 row_mask:0xf bank_mask:0xf
    v_add_f32_dpp v108, v108, v108 row_ror:4 row_mask:0xf bank_mask:0xf
    v_add_f32_dpp v96, v96, v96 row_ror:2 row_mask:0xf bank_mask:0xf
    v_add_f32_dpp v100, v100, v100 row_ror:2 row_mask:0xf bank_mask:0xf
    v_add_f32_dpp v104, v104, v104 row_ror:2 row_mask:0xf bank_mask:0xf
    v_add_f32_dpp v108, v108, v108 row_ror:2 row_mask:0xf bank_mask:0xf
    v_add_f32_dpp v96, v96, v96 row_ror:1 row_mask:0xf bank_mask:0xf
    v_add_f32_dpp v100, v100, v100 row_ror:1 row_mask:0xf bank_mask:0xf
    v_add_f32_dpp v104, v104, v104 row_ror:1 row_mask:0xf bank_mask:0xf
    v_add_f32_dpp v108, v108, v108 row_ror:1 row_mask:0xf bank_mask:0xf
    v_cvt_pk_bf16_f32 v100, v96, v100
    v_cvt_pk_bf16_f32 v108, v104, v108
    v_lshlrev_b32 v96, 16, v100
    v_and_b32 v100, s46, v100
    v_lshlrev_b32 v104, 16, v108
    v_and_b32 v108, s46, v108
    v_mul_f32 v96, s47, v96
    v_mul_f32 v100, s47, v100
    v_mul_f32 v104, s47, v104
    v_mul_f32 v108, s47, v108
    v_cvt_pk_bf16_f32 v100, v96, v100
    v_cvt_pk_bf16_f32 v108, v104, v108
    v_lshlrev_b32 v96, 16, v100
    v_and_b32 v100, s46, v100
    v_lshlrev_b32 v104, 16, v108
    v_and_b32 v108, s46, v108
    s_waitcnt vmcnt(0)
    v_dot2_f32_bf16 v112, v112, v6, 0
    v_dot2_f32_bf16 v116, v116, v6, 0
    v_dot2_f32_bf16 v120, v120, v6, 0
    v_dot2_f32_bf16 v124, v124, v6, 0
    v_dot2_f32_bf16 v112, v113, v7, v112
    v_dot2_f32_bf16 v116, v117, v7, v116
    v_dot2_f32_bf16 v120, v121, v7, v120
    v_dot2_f32_bf16 v124, v125, v7, v124
    v_dot2_f32_bf16 v112, v114, v8, v112
    v_dot2_f32_bf16 v116, v118, v8, v116
    v_dot2_f32_bf16 v120, v122, v8, v120
    v_dot2_f32_bf16 v124, v126, v8, v124
    v_dot2_f32_bf16 v112, v115, v9, v112
    v_dot2_f32_bf16 v116, v119, v9, v116
    v_dot2_f32_bf16 v120, v123, v9, v120
    v_dot2_f32_bf16 v124, v127, v9, v124
    v_add_f32_dpp v112, v112, v112 row_ror:8 row_mask:0xf bank_mask:0xf
    v_add_f32_dpp v116, v116, v116 row_ror:8 row_mask:0xf bank_mask:0xf
    v_add_f32_dpp v120, v120, v120 row_ror:8 row_mask:0xf bank_mask:0xf
    v_add_f32_dpp v124, v124, v124 row_ror:8 row_mask:0xf bank_mask:0xf
    v_add_f32_dpp v112, v112, v112 row_ror:4 row_mask:0xf bank_mask:0xf
    v_add_f32_dpp v116, v116, v116 row_ror:4 row_mask:0xf bank_mask:0xf
    v_add_f32_dpp v120, v120, v120 row_ror:4 row_mask:0xf bank_mask:0xf
    v_add_f32_dpp v124, v124, v124 row_ror:4 row_mask:0xf bank_mask:0xf
    v_add_f32_dpp v112, v112, v112 row_ror:2 row_mask:0xf bank_mask:0xf
    v_add_f32_dpp v116, v116, v116 row_ror:2 row_mask:0xf bank_mask:0xf
    v_add_f32_dpp v120, v120, v120 row_ror:2 row_mask:0xf bank_mask:0xf
    v_add_f32_dpp v124, v124, v124 row_ror:2 row_mask:0xf bank_mask:0xf
    v_add_f32_dpp v112, v112, v112 row_ror:1 row_mask:0xf bank_mask:0xf
    v_add_f32_dpp v116, v116, v116 row_ror:1 row_mask:0xf bank_mask:0xf
    v_add_f32_dpp v120, v120, v120 row_ror:1 row_mask:0xf bank_mask:0xf
    v_add_f32_dpp v124, v124, v124 row_ror:1 row_mask:0xf bank_mask:0xf
    v_cvt_pk_bf16_f32 v116, v112, v116
    v_cvt_pk_bf16_f32 v124, v120, v124
    v_lshlrev_b32 v112, 16, v116
    v_and_b32 v116, s46, v116
    v_lshlrev_b32 v120, 16, v124
    v_and_b32 v124, s46, v124
    v_mul_f32 v112, s47, v112
    v_mul_f32 v116, s47, v116
    v_mul_f32 v120, s47, v120
    v_mul_f32 v124, s47, v124
    v_cvt_pk_bf16_f32 v116, v112, v116
    v_cvt_pk_bf16_f32 v124, v120, v124
    v_lshlrev_b32 v112, 16, v116
    v_and_b32 v116, s46, v116
    v_lshlrev_b32 v120, 16, v124
    v_and_b32 v124, s46, v124
    s_and_b32 s43, s69, 0xff
    v_max3_f32 v6, v64, v68, v72
    v_max3_f32 v7, v76, v80, v84
    v_max3_f32 v8, v88, v92, v96
    v_max3_f32 v9, v100, v104, v108
    v_max3_f32 v10, v112, v116, v120
    v_max3_f32 v6, v6, v7, v124
    v_max3_f32 v8, v8, v9, v10
    v_max_f32 v30, v6, v8
    v_mov_b32 v6, v30
    s_nop 1
    v_permlane16_swap_b32 v30, v6
    v_max_f32 v30, v30, v6
    v_mov_b32 v6, v30
    s_nop 1
    v_permlane32_swap_b32 v30, v6
    v_max_f32 v30, v30, v6
    v_mul_f32 v30, s48, v30
    v_fma_f32 v64, v64, s48, -v30
    v_fma_f32 v68, v68, s48, -v30
    v_fma_f32 v72, v72, s48, -v30
    v_fma_f32 v76, v76, s48, -v30
    v_fma_f32 v80, v80, s48, -v30
    v_fma_f32 v84, v84, s48, -v30
    v_fma_f32 v88, v88, s48, -v30
    v_fma_f32 v92, v92, s48, -v30
    v_fma_f32 v96, v96, s48, -v30
    v_fma_f32 v100, v100, s48, -v30
    v_fma_f32 v104, v104, s48, -v30
    v_fma_f32 v108, v108, s48, -v30
    v_fma_f32 v112, v112, s48, -v30
    v_fma_f32 v116, v116, s48, -v30
    v_fma_f32 v120, v120, s48, -v30
    v_fma_f32 v124, v124, s48, -v30
    v_exp_f32 v64, v64
    v_exp_f32 v68, v68
    v_exp_f32 v72, v72
    v_exp_f32 v76, v76
    v_exp_f32 v80, v80
    v_exp_f32 v84, v84
    v_exp_f32 v88, v88
    v_exp_f32 v92, v92
    v_exp_f32 v96, v96
    v_exp_f32 v100, v100
    v_exp_f32 v104, v104
    v_exp_f32 v108, v108
    v_exp_f32 v112, v112
    v_exp_f32 v116, v116
    v_exp_f32 v120, v120
    v_exp_f32 v124, v124
    v_add_f32 v65, v64, v68
    v_add_f32 v73, v72, v76
    v_add_f32 v81, v80, v84
    v_add_f32 v89, v88, v92
    v_add_f32 v97, v96, v100
    v_add_f32 v105, v104, v108
    v_add_f32 v113, v112, v116
    v_add_f32 v121, v120, v124
    v_add_f32 v65, v65, v73
    v_add_f32 v81, v81, v89
    v_add_f32 v97, v97, v105
    v_add_f32 v113, v113, v121
    v_add_f32 v65, v65, v81
    v_add_f32 v97, v97, v113
    v_add_f32 v65, v65, v97
    v_mov_b32 v31, v65
    v_mov_b32 v6, v31
    s_nop 1
    v_permlane16_swap_b32 v31, v6
    v_add_f32 v31, v31, v6
    v_mov_b32 v6, v31
    s_nop 1
    v_permlane32_swap_b32 v31, v6
    v_add_f32 v31, v31, v6
    s_lshl_b32 s59, s3, 3
    v_mov_b32 v6, s59
    v_mov_b32 v7, 1
    s_mov_b64 exec, 1
    ds_write_b64 v6, v[30:31] offset:10240
    ds_add_rtn_u32 v8, v11, v7 offset:10728
    s_mov_b64 exec, -1
    v_mov_b32 v18, 0
    v_mov_b32 v19, 0
    v_mov_b32 v20, 0
    v_mov_b32 v21, 0
    s_cmp_eq_u32 s30, 0
    s_cbranch_scc1 L_noffn
    v_lshlrev_b32 v9, 3, v2
L_hw:
    ds_read_b32 v10, v11 offset:10724
    ds_read_b64 v[12:13], v9 offset:10624
    s_waitcnt lgkmcnt(0)
    v_readfirstlane_b32 s59, v10
    s_nop 0
    s_cmp_eq_u32 s59, 1
    s_cbranch_scc1 L_hwok
    s_sleep 2
    s_sub_u32 s71, s71, 1
    s_cbranch_scc0 L_hw
    s_endpgm
L_hwok:
    v_perm_b32 v14, v24, v22, s44
    v_perm_b32 v24, v24, v22, s45
    v_perm_b32 v15, v25, v23, s44
    v_perm_b32 v25, v25, v23, s45
    v_perm_b32 v16, v28, v26, s44
    v_perm_b32 v28, v28, v26, s45
    v_perm_b32 v17, v29, v27, s44
    v_perm_b32 v29, v29, v27, s45
    v_dot2_f32_bf16 v18, v14, v12, v18
    v_dot2_f32_bf16 v19, v24, v12, v19
    v_dot2_f32_bf16 v20, v15, v12, v20
    v_dot2_f32_bf16 v21, v25, v12, v21
    v_dot2_f32_bf16 v18, v16, v13, v18
    v_dot2_f32_bf16 v19, v28, v13, v19
    v_dot2_f32_bf16 v20, v17, v13, v20
    v_dot2_f32_bf16 v21, v29, v13, v21
L_noffn:
    v_cvt_pk_bf16_f32 v22, v64, v68
    v_cvt_pk_bf16_f32 v23, v72, v76
    v_cvt_pk_bf16_f32 v24, v80, v84
    v_cvt_pk_bf16_f32 v25, v88, v92
    v_cvt_pk_bf16_f32 v26, v96, v100
    v_cvt_pk_bf16_f32 v27, v104, v108
    v_cvt_pk_bf16_f32 v28, v112, v116
    v_cvt_pk_bf16_f32 v29, v120, v124
    s_waitcnt lgkmcnt(0)
    v_readfirstlane_b32 s59, v8
    s_nop 0
    s_cmp_lg_u32 s59, 15
    s_cbranch_scc1 L_noml
    s_setprio 3
    v_lshlrev_b32 v6, 3, v3
    ds_read_b64 v[8:9], v6 offset:10240
    v_mov_b32 v11, s69
    v_mov_b32 v13, s69
    s_waitcnt lgkmcnt(0)
    v_mov_b32 v10, v8
    s_nop 1
    v_max_f32_dpp v10, v10, v10 row_ror:8 row_mask:0xf bank_mask:0xf
    s_nop 1
    v_max_f32_dpp v10, v10, v10 row_ror:4 row_mask:0xf bank_mask:0xf
    s_nop 1
    v_max_f32_dpp v10, v10, v10 row_ror:2 row_mask:0xf bank_mask:0xf
    s_nop 1
    v_max_f32_dpp v10, v10, v10 row_ror:1 row_mask:0xf bank_mask:0xf
    v_sub_f32 v8, v8, v10
    v_exp_f32 v8, v8
    s_nop 0
    v_mul_f32 v12, v8, v9
    s_nop 1
    v_add_f32_dpp v12, v12, v12 row_ror:8 row_mask:0xf bank_mask:0xf
    s_nop 1
    v_add_f32_dpp v12, v12, v12 row_ror:4 row_mask:0xf bank_mask:0xf
    s_nop 1
    v_add_f32_dpp v12, v12, v12 row_ror:2 row_mask:0xf bank_mask:0xf
    s_nop 1
    v_add_f32_dpp v12, v12, v12 row_ror:1 row_mask:0xf bank_mask:0xf
    s_lshl4_add_u32 s59, s67, s57
    s_mov_b64 exec, 1
    buffer_store_dwordx4 v[10:13], off, s[36:39], s59 sc1
    s_mov_b64 exec, -1
    s_nop 1
L_noml:
    s_setprio 0
    s_lshl_b32 s61, s3, 2
    v_mov_b32 v30, s61
    s_cmp_ge_u32 s3, 8
    s_cbranch_scc1 L_nwave
    v_mul_u32_u24 v31, 2560, v2
    v_lshl_add_u32 v31, v3, 3, v31
    s_xor_b32 s50, s49, 0
    buffer_load_dwordx4 v[64:67], v4, s[16:19], s50 offen nt
    s_xor_b32 s50, s49, 1024
    buffer_load_dwordx4 v[68:71], v4, s[16:19], s50 offen nt
    s_xor_b32 s50, s49, 2048
    buffer_load_dwordx4 v[72:75], v4, s[16:19], s50 offen nt
    s_xor_b32 s50, s49, 3072
    buffer_load_dwordx4 v[76:79], v4, s[16:19], s50 offen nt
    s_xor_b32 s50, s49, 65536
    buffer_load_dwordx4 v[80:83], v4, s[16:19], s50 offen nt
    s_xor_b32 s50, s49, 66560
    buffer_load_dwordx4 v[84:87], v4, s[16:19], s50 offen nt
    s_xor_b32 s50, s49, 67584
    buffer_load_dwordx4 v[88:91], v4, s[16:19], s50 offen nt
    s_xor_b32 s50, s49, 68608
    buffer_load_dwordx4 v[92:95], v4, s[16:19], s50 offen nt
    s_xor_b32 s50, s49, 131072
    buffer_load_dwordx4 v[96:99], v4, s[16:19], s50 offen nt
    s_xor_b32 s50, s49, 132096
    buffer_load_dwordx4 v[100:103], v4, s[16:19], s50 offen nt
    s_xor_b32 s50, s49, 133120
    buffer_load_dwordx4 v[104:107], v4, s[16:19], s50 offen nt
    s_xor_b32 s50, s49, 134144
    buffer_load_dwordx4 v[108:111], v4, s[16:19], s50 offen nt
    s_xor_b32 s50, s49, 196608
    buffer_load_dwordx4 v[112:115], v4, s[16:19], s50 offen nt
    s_xor_b32 s50, s49, 197632
    buffer_load_dwordx4 v[116:119], v4, s[16:19], s50 offen nt
    s_xor_b32 s50, s49, 198656
    buffer_load_dwordx4 v[120:123], v4, s[16:19], s50 offen nt
    s_xor_b32 s50, s49, 199680
    buffer_load_dwordx4 v[124:127], v4, s[16:19], s50 offen nt
    s_waitcnt vmcnt(14)
    v_perm_b32 v6, v68, v64, s44
    v_perm_b32 v68, v68, v64, s45
    v_dot2_f32_bf16 v10, v6, v22, 0
    v_dot2_f32_bf16 v11, v68, v22, 0
    v_perm_b32 v7, v69, v65, s44
    v_perm_b32 v69, v69, v65, s45
    v_dot2_f32_bf16 v12, v7, v22, 0
    v_dot2_f32_bf16 v13, v69, v22, 0
    v_perm_b32 v8, v70, v66, s44
    v_perm_b32 v70, v70, v66, s45
    v_dot2_f32_bf16 v14, v8, v22, 0
    v_dot2_f32_bf16 v15, v70, v22, 0
    v_perm_b32 v6, v71, v67, s44
    v_perm_b32 v71, v71, v67, s45
    v_dot2_f32_bf16 v16, v6, v22, 0
    v_dot2_f32_bf16 v17, v71, v22, 0
    s_add_u32 s60, s64, 81920
    buffer_load_dwordx2 v[64:65], v31, s[24:27], s60 offen offset:0
    buffer_load_dwordx2 v[66:67], v31, s[24:27], s60 offen offset:1280
    s_add_u32 s60, s64, 92160
    buffer_load_dwordx2 v[68:69], v31, s[24:27], s60 offen offset:0
    buffer_load_dwordx2 v[70:71], v31, s[24:27], s60 offen offset:1280
    s_waitcnt vmcnt(16)
    v_perm_b32 v6, v76, v72, s44
    v_perm_b32 v76, v76, v72, s45
    v_dot2_f32_bf16 v10, v6, v23, v10
    v_dot2_f32_bf16 v11, v76, v23, v11
    v_perm_b32 v7, v77, v73, s44
    v_perm_b32 v77, v77, v73, s45
    v_dot2_f32_bf16 v12, v7, v23, v12
    v_dot2_f32_bf16 v13, v77, v23, v13
    v_perm_b32 v8, v78, v74, s44
    v_perm_b32 v78, v78, v74, s45
    v_dot2_f32_bf16 v14, v8, v23, v14
    v_dot2_f32_bf16 v15, v78, v23, v15
    v_perm_b32 v6, v79, v75, s44
    v_perm_b32 v79, v79, v75, s45
    v_dot2_f32_bf16 v16, v6, v23, v16
    v_dot2_f32_bf16 v17, v79, v23, v17
    s_add_u32 s60, s64, 102400
    buffer_load_dwordx2 v[72:73], v31, s[24:27], s60 offen offset:0
    buffer_load_dwordx2 v[74:75], v31, s[24:27], s60 offen offset:1280
    s_add_u32 s60, s64, 112640
    buffer_load_dwordx2 v[76:77], v31, s[24:27], s60 offen offset:0
    buffer_load_dwordx2 v[78:79], v31, s[24:27], s60 offen offset:1280
    s_waitcnt vmcnt(18)
    v_perm_b32 v6, v84, v80, s44
    v_perm_b32 v84, v84, v80, s45
    v_dot2_f32_bf16 v10, v6, v24, v10
    v_dot2_f32_bf16 v11, v84, v24, v11
    v_perm_b32 v7, v85, v81, s44
    v_perm_b32 v85, v85, v81, s45
    v_dot2_f32_bf16 v12, v7, v24, v12
    v_dot2_f32_bf16 v13, v85, v24, v13
    v_perm_b32 v8, v86, v82, s44
    v_perm_b32 v86, v86, v82, s45
    v_dot2_f32_bf16 v14, v8, v24, v14
    v_dot2_f32_bf16 v15, v86, v24, v15
    v_perm_b32 v6, v87, v83, s44
    v_perm_b32 v87, v87, v83, s45
    v_dot2_f32_bf16 v16, v6, v24, v16
    v_dot2_f32_bf16 v17, v87, v24, v17
    s_add_u32 s60, s64, 122880
    buffer_load_dwordx2 v[80:81], v31, s[24:27], s60 offen offset:0
    buffer_load_dwordx2 v[82:83], v31, s[24:27], s60 offen offset:1280
    s_add_u32 s60, s64, 133120
    buffer_load_dwordx2 v[84:85], v31, s[24:27], s60 offen offset:0
    buffer_load_dwordx2 v[86:87], v31, s[24:27], s60 offen offset:1280
    s_waitcnt vmcnt(20)
    v_perm_b32 v6, v92, v88, s44
    v_perm_b32 v92, v92, v88, s45
    v_dot2_f32_bf16 v10, v6, v25, v10
    v_dot2_f32_bf16 v11, v92, v25, v11
    v_perm_b32 v7, v93, v89, s44
    v_perm_b32 v93, v93, v89, s45
    v_dot2_f32_bf16 v12, v7, v25, v12
    v_dot2_f32_bf16 v13, v93, v25, v13
    v_perm_b32 v8, v94, v90, s44
    v_perm_b32 v94, v94, v90, s45
    v_dot2_f32_bf16 v14, v8, v25, v14
    v_dot2_f32_bf16 v15, v94, v25, v15
    v_perm_b32 v6, v95, v91, s44
    v_perm_b32 v95, v95, v91, s45
    v_dot2_f32_bf16 v16, v6, v25, v16
    v_dot2_f32_bf16 v17, v95, v25, v17
    s_add_u32 s60, s64, 143360
    buffer_load_dwordx2 v[88:89], v31, s[24:27], s60 offen offset:0
    buffer_load_dwordx2 v[90:91], v31, s[24:27], s60 offen offset:1280
    s_add_u32 s60, s64, 153600
    buffer_load_dwordx2 v[92:93], v31, s[24:27], s60 offen offset:0
    buffer_load_dwordx2 v[94:95], v31, s[24:27], s60 offen offset:1280
    s_waitcnt vmcnt(22)
    v_perm_b32 v6, v100, v96, s44
    v_perm_b32 v100, v100, v96, s45
    v_dot2_f32_bf16 v10, v6, v26, v10
    v_dot2_f32_bf16 v11, v100, v26, v11
    v_perm_b32 v7, v101, v97, s44
    v_perm_b32 v101, v101, v97, s45
    v_dot2_f32_bf16 v12, v7, v26, v12
    v_dot2_f32_bf16 v13, v101, v26, v13
    v_perm_b32 v8, v102, v98, s44
    v_perm_b32 v102, v102, v98, s45
    v_dot2_f32_bf16 v14, v8, v26, v14
    v_dot2_f32_bf16 v15, v102, v26, v15
    v_perm_b32 v6, v103, v99, s44
    v_perm_b32 v103, v103, v99, s45
    v_dot2_f32_bf16 v16, v6, v26, v16
    v_dot2_f32_bf16 v17, v103, v26, v17
    s_waitcnt vmcnt(20)
    v_perm_b32 v6, v108, v104, s44
    v_perm_b32 v108, v108, v104, s45
    v_dot2_f32_bf16 v10, v6, v27, v10
    v_dot2_f32_bf16 v11, v108, v27, v11
    v_perm_b32 v7, v109, v105, s44
    v_perm_b32 v109, v109, v105, s45
    v_dot2_f32_bf16 v12, v7, v27, v12
    v_dot2_f32_bf16 v13, v109, v27, v13
    v_perm_b32 v8, v110, v106, s44
    v_perm_b32 v110, v110, v106, s45
    v_dot2_f32_bf16 v14, v8, v27, v14
    v_dot2_f32_bf16 v15, v110, v27, v15
    v_perm_b32 v6, v111, v107, s44
    v_perm_b32 v111, v111, v107, s45
    v_dot2_f32_bf16 v16, v6, v27, v16
    v_dot2_f32_bf16 v17, v111, v27, v17
    s_waitcnt vmcnt(18)
    v_perm_b32 v6, v116, v112, s44
    v_perm_b32 v116, v116, v112, s45
    v_dot2_f32_bf16 v10, v6, v28, v10
    v_dot2_f32_bf16 v11, v116, v28, v11
    v_perm_b32 v7, v117, v113, s44
    v_perm_b32 v117, v117, v113, s45
    v_dot2_f32_bf16 v12, v7, v28, v12
    v_dot2_f32_bf16 v13, v117, v28, v13
    v_perm_b32 v8, v118, v114, s44
    v_perm_b32 v118, v118, v114, s45
    v_dot2_f32_bf16 v14, v8, v28, v14
    v_dot2_f32_bf16 v15, v118, v28, v15
    v_perm_b32 v6, v119, v115, s44
    v_perm_b32 v119, v119, v115, s45
    v_dot2_f32_bf16 v16, v6, v28, v16
    v_dot2_f32_bf16 v17, v119, v28, v17
    s_waitcnt vmcnt(16)
    v_perm_b32 v6, v124, v120, s44
    v_perm_b32 v124, v124, v120, s45
    v_dot2_f32_bf16 v10, v6, v29, v10
    v_dot2_f32_bf16 v11, v124, v29, v11
    v_perm_b32 v7, v125, v121, s44
    v_perm_b32 v125, v125, v121, s45
    v_dot2_f32_bf16 v12, v7, v29, v12
    v_dot2_f32_bf16 v13, v125, v29, v13
    v_perm_b32 v8, v126, v122, s44
    v_perm_b32 v126, v126, v122, s45
    v_dot2_f32_bf16 v14, v8, v29, v14
    v_dot2_f32_bf16 v15, v126, v29, v15
    v_perm_b32 v6, v127, v123, s44
    v_perm_b32 v127, v127, v123, s45
    v_dot2_f32_bf16 v16, v6, v29, v16
    v_dot2_f32_bf16 v17, v127, v29, v17
    s_branch L_pvdone
L_nwave:
    s_mul_i32 s59, s3, 272
    v_lshl_add_u32 v31, v1, 2, s59
    s_xor_b32 s50, s49, 0
    buffer_load_dwordx4 v[64:67], v4, s[16:19], s50 offen nt
    s_xor_b32 s50, s49, 1024
    buffer_load_dwordx4 v[68:71], v4, s[16:19], s50 offen nt
    s_xor_b32 s50, s49, 2048
    buffer_load_dwordx4 v[72:75], v4, s[16:19], s50 offen nt
    s_xor_b32 s50, s49, 3072
    buffer_load_dwordx4 v[76:79], v4, s[16:19], s50 offen nt
    s_xor_b32 s50, s49, 65536
    buffer_load_dwordx4 v[80:83], v4, s[16:19], s50 offen nt
    s_xor_b32 s50, s49, 66560
    buffer_load_dwordx4 v[84:87], v4, s[16:19], s50 offen nt
    s_xor_b32 s50, s49, 67584
    buffer_load_dwordx4 v[88:91], v4, s[16:19], s50 offen nt
    s_xor_b32 s50, s49, 68608
    buffer_load_dwordx4 v[92:95], v4, s[16:19], s50 offen nt
    s_xor_b32 s50, s49, 131072
    buffer_load_dwordx4 v[96:99], v4, s[16:19], s50 offen nt
    s_xor_b32 s50, s49, 132096
    buffer_load_dwordx4 v[100:103], v4, s[16:19], s50 offen nt
    s_xor_b32 s50, s49, 133120
    buffer_load_dwordx4 v[104:107], v4, s[16:19], s50 offen nt
    s_xor_b32 s50, s49, 134144
    buffer_load_dwordx4 v[108:111], v4, s[16:19], s50 offen nt
    s_xor_b32 s50, s49, 196608
    buffer_load_dwordx4 v[112:115], v4, s[16:19], s50 offen nt
    s_xor_b32 s50, s49, 197632
    buffer_load_dwordx4 v[116:119], v4, s[16:19], s50 offen nt
    s_xor_b32 s50, s49, 198656
    buffer_load_dwordx4 v[120:123], v4, s[16:19], s50 offen nt
    s_xor_b32 s50, s49, 199680
    buffer_load_dwordx4 v[124:127], v4, s[16:19], s50 offen nt
    s_waitcnt vmcnt(14)
    v_perm_b32 v6, v68, v64, s44
    v_perm_b32 v68, v68, v64, s45
    v_dot2_f32_bf16 v10, v6, v22, 0
    v_dot2_f32_bf16 v11, v68, v22, 0
    v_perm_b32 v7, v69, v65, s44
    v_perm_b32 v69, v69, v65, s45
    v_dot2_f32_bf16 v12, v7, v22, 0
    v_dot2_f32_bf16 v13, v69, v22, 0
    v_perm_b32 v8, v70, v66, s44
    v_perm_b32 v70, v70, v66, s45
    v_dot2_f32_bf16 v14, v8, v22, 0
    v_dot2_f32_bf16 v15, v70, v22, 0
    v_perm_b32 v6, v71, v67, s44
    v_perm_b32 v71, v71, v67, s45
    v_dot2_f32_bf16 v16, v6, v22, 0
    v_dot2_f32_bf16 v17, v71, v22, 0
    s_waitcnt vmcnt(12)
    v_perm_b32 v6, v76, v72, s44
    v_perm_b32 v76, v76, v72, s45
    v_dot2_f32_bf16 v10, v6, v23, v10
    v_dot2_f32_bf16 v11, v76, v23, v11
    v_perm_b32 v7, v77, v73, s44
    v_perm_b32 v77, v77, v73, s45
    v_dot2_f32_bf16 v12, v7, v23, v12
    v_dot2_f32_bf16 v13, v77, v23, v13
    v_perm_b32 v8, v78, v74, s44
    v_perm_b32 v78, v78, v74, s45
    v_dot2_f32_bf16 v14, v8, v23, v14
    v_dot2_f32_bf16 v15, v78, v23, v15
    v_perm_b32 v6, v79, v75, s44
    v_perm_b32 v79, v79, v75, s45
    v_dot2_f32_bf16 v16, v6, v23, v16
    v_dot2_f32_bf16 v17, v79, v23, v17
    s_waitcnt vmcnt(10)
    v_perm_b32 v6, v84, v80, s44
    v_perm_b32 v84, v84, v80, s45
    v_dot2_f32_bf16 v10, v6, v24, v10
    v_dot2_f32_bf16 v11, v84, v24, v11
    v_perm_b32 v7, v85, v81, s44
    v_perm_b32 v85, v85, v81, s45
    v_dot2_f32_bf16 v12, v7, v24, v12
    v_dot2_f32_bf16 v13, v85, v24, v13
    v_perm_b32 v8, v86, v82, s44
    v_perm_b32 v86, v86, v82, s45
    v_dot2_f32_bf16 v14, v8, v24, v14
    v_dot2_f32_bf16 v15, v86, v24, v15
    v_perm_b32 v6, v87, v83, s44
    v_perm_b32 v87, v87, v83, s45
    v_dot2_f32_bf16 v16, v6, v24, v16
    v_dot2_f32_bf16 v17, v87, v24, v17
    s_waitcnt vmcnt(8)
    v_perm_b32 v6, v92, v88, s44
    v_perm_b32 v92, v92, v88, s45
    v_dot2_f32_bf16 v10, v6, v25, v10
    v_dot2_f32_bf16 v11, v92, v25, v11
    v_perm_b32 v7, v93, v89, s44
    v_perm_b32 v93, v93, v89, s45
    v_dot2_f32_bf16 v12, v7, v25, v12
    v_dot2_f32_bf16 v13, v93, v25, v13
    v_perm_b32 v8, v94, v90, s44
    v_perm_b32 v94, v94, v90, s45
    v_dot2_f32_bf16 v14, v8, v25, v14
    v_dot2_f32_bf16 v15, v94, v25, v15
    v_perm_b32 v6, v95, v91, s44
    v_perm_b32 v95, v95, v91, s45
    v_dot2_f32_bf16 v16, v6, v25, v16
    v_dot2_f32_bf16 v17, v95, v25, v17
    s_waitcnt vmcnt(6)
    v_perm_b32 v6, v100, v96, s44
    v_perm_b32 v100, v100, v96, s45
    v_dot2_f32_bf16 v10, v6, v26, v10
    v_dot2_f32_bf16 v11, v100, v26, v11
    v_perm_b32 v7, v101, v97, s44
    v_perm_b32 v101, v101, v97, s45
    v_dot2_f32_bf16 v12, v7, v26, v12
    v_dot2_f32_bf16 v13, v101, v26, v13
    v_perm_b32 v8, v102, v98, s44
    v_perm_b32 v102, v102, v98, s45
    v_dot2_f32_bf16 v14, v8, v26, v14
    v_dot2_f32_bf16 v15, v102, v26, v15
    v_perm_b32 v6, v103, v99, s44
    v_perm_b32 v103, v103, v99, s45
    v_dot2_f32_bf16 v16, v6, v26, v16
    v_dot2_f32_bf16 v17, v103, v26, v17
    s_waitcnt vmcnt(4)
    v_perm_b32 v6, v108, v104, s44
    v_perm_b32 v108, v108, v104, s45
    v_dot2_f32_bf16 v10, v6, v27, v10
    v_dot2_f32_bf16 v11, v108, v27, v11
    v_perm_b32 v7, v109, v105, s44
    v_perm_b32 v109, v109, v105, s45
    v_dot2_f32_bf16 v12, v7, v27, v12
    v_dot2_f32_bf16 v13, v109, v27, v13
    v_perm_b32 v8, v110, v106, s44
    v_perm_b32 v110, v110, v106, s45
    v_dot2_f32_bf16 v14, v8, v27, v14
    v_dot2_f32_bf16 v15, v110, v27, v15
    v_perm_b32 v6, v111, v107, s44
    v_perm_b32 v111, v111, v107, s45
    v_dot2_f32_bf16 v16, v6, v27, v16
    v_dot2_f32_bf16 v17, v111, v27, v17
    s_waitcnt vmcnt(2)
    v_perm_b32 v6, v116, v112, s44
    v_perm_b32 v116, v116, v112, s45
    v_dot2_f32_bf16 v10, v6, v28, v10
    v_dot2_f32_bf16 v11, v116, v28, v11
    v_perm_b32 v7, v117, v113, s44
    v_perm_b32 v117, v117, v113, s45
    v_dot2_f32_bf16 v12, v7, v28, v12
    v_dot2_f32_bf16 v13, v117, v28, v13
    v_perm_b32 v8, v118, v114, s44
    v_perm_b32 v118, v118, v114, s45
    v_dot2_f32_bf16 v14, v8, v28, v14
    v_dot2_f32_bf16 v15, v118, v28, v15
    v_perm_b32 v6, v119, v115, s44
    v_perm_b32 v119, v119, v115, s45
    v_dot2_f32_bf16 v16, v6, v28, v16
    v_dot2_f32_bf16 v17, v119, v28, v17
    s_waitcnt vmcnt(0)
    v_perm_b32 v6, v124, v120, s44
    v_perm_b32 v124, v124, v120, s45
    v_dot2_f32_bf16 v10, v6, v29, v10
    v_dot2_f32_bf16 v11, v124, v29, v11
    v_perm_b32 v7, v125, v121, s44
    v_perm_b32 v125, v125, v121, s45
    v_dot2_f32_bf16 v12, v7, v29, v12
    v_dot2_f32_bf16 v13, v125, v29, v13
    v_perm_b32 v8, v126, v122, s44
    v_perm_b32 v126, v126, v122, s45
    v_dot2_f32_bf16 v14, v8, v29, v14
    v_dot2_f32_bf16 v15, v126, v29, v15
    v_perm_b32 v6, v127, v123, s44
    v_perm_b32 v127, v127, v123, s45
    v_dot2_f32_bf16 v16, v6, v29, v16
    v_dot2_f32_bf16 v17, v127, v29, v17
L_pvdone:
    s_cmp_lg_u32 s3, 0
    s_cbranch_scc1 L_nof
    s_setprio 3
    v_lshlrev_b32 v96, 4, v1
    s_mov_b64 exec, 0xf
    buffer_load_dwordx4 v[100:103], v96, s[36:39], s57 offen
    s_branch L_ml1
L_mlloop:
    s_sleep 4
    buffer_load_dwordx4 v[100:103], v96, s[36:39], s57 offen sc1
L_ml1:
    s_waitcnt vmcnt(0)
    v_cmp_ne_u32 vcc, s69, v101
    v_cmp_ne_u32 s[4:5], s69, v103
    s_nop 0
    s_or_b64 vcc, vcc, s[4:5]
    s_cbranch_scc0 L_mlok
    s_sub_u32 s71, s71, 1
    s_cbranch_scc0 L_mlloop
    s_endpgm
L_mlok:
    v_max_f32_dpp v99, v100, v100 quad_perm:[1,0,3,2] row_mask:0xf bank_mask:0xf
    s_nop 1
    v_max_f32_dpp v99, v99, v99 quad_perm:[2,3,0,1] row_mask:0xf bank_mask:0xf
    v_sub_f32 v100, v100, v99
    v_exp_f32 v100, v100
    s_nop 0
    v_mul_f32 v100, v100, v102
    s_nop 1
    v_add_f32_dpp v100, v100, v100 quad_perm:[1,0,3,2] row_mask:0xf bank_mask:0xf
    s_nop 1
    v_add_f32_dpp v100, v100, v100 quad_perm:[2,3,0,1] row_mask:0xf bank_mask:0xf
    v_rcp_f32 v100, v100
    v_readfirstlane_b32 s4, v99
    v_readfirstlane_b32 s5, v100
    s_mov_b64 exec, -1
    v_lshlrev_b32 v97, 3, v3
    ds_read_b32 v98, v97 offset:10240
    s_waitcnt lgkmcnt(0)
    v_subrev_f32 v98, s4, v98
    v_exp_f32 v98, v98
    s_nop 0
    v_mul_f32 v98, s5, v98
    v_lshlrev_b32 v97, 2, v3
    v_mov_b32 v99, 1
    s_mov_b64 exec, 0xffff
    ds_write_b32 v97, v98 offset:10656
    s_mov_b64 exec, 0xf
    ds_write_b32 v97, v99 offset:10736
    s_mov_b64 exec, -1
    s_setprio 0
L_nof:
L_ch:
    ds_read_b32 v22, v30 offset:10736
    ds_read_b32 v23, v30 offset:10656
    ds_read_b64 v[24:25], v0 offset:0
    s_cmp_eq_u32 s61, -1
    s_cbranch_scc1 L_chred
    v_permlane32_swap_b32 v10, v14
    v_permlane32_swap_b32 v11, v15
    v_permlane32_swap_b32 v12, v16
    v_permlane32_swap_b32 v13, v17
    v_add_f32 v10, v10, v14
    v_add_f32 v11, v11, v15
    v_add_f32 v12, v12, v16
    v_add_f32 v13, v13, v17
    s_nop 0
    v_permlane16_swap_b32 v10, v12
    v_permlane16_swap_b32 v11, v13
    v_add_f32 v10, v10, v12
    v_add_f32 v11, v11, v13
    s_mov_b32 s61, -1
L_chred:
    s_waitcnt lgkmcnt(0)
    v_readfirstlane_b32 s59, v22
    s_nop 0
    s_cmp_eq_u32 s59, 1
    s_cbranch_scc1 L_chok
    s_sleep 1
    s_sub_u32 s71, s71, 1
    s_cbranch_scc0 L_ch
    s_endpgm
L_chok:
    s_cmp_ge_u32 s3, 4
    s_cbranch_scc1 L_chadd
    v_mov_b32 v24, 0
    v_mov_b32 v25, 0
L_chadd:
    v_fmac_f32 v24, v10, v23
    v_fmac_f32 v25, v11, v23
    s_cmp_ge_u32 s3, 12
    s_cbranch_scc1 L_bar3
    ds_write_b64 v0, v[24:25] offset:2048
    s_mov_b64 exec, 1
    ds_write_b32 v30, v22 offset:10752
    s_mov_b64 exec, -1
    s_waitcnt vmcnt(0)
    v_perm_b32 v112, v34, v32, s44
    v_perm_b32 v116, v34, v32, s45
    v_perm_b32 v120, v35, v33, s44
    v_perm_b32 v124, v35, v33, s45
    v_perm_b32 v113, v38, v36, s44
    v_perm_b32 v117, v38, v36, s45
    v_perm_b32 v121, v39, v37, s44
    v_perm_b32 v125, v39, v37, s45
    v_perm_b32 v114, v42, v40, s44
    v_perm_b32 v118, v42, v40, s45
    v_perm_b32 v122, v43, v41, s44
    v_perm_b32 v126, v43, v41, s45
    v_perm_b32 v115, v46, v44, s44
    v_perm_b32 v119, v46, v44, s45
    v_perm_b32 v123, v47, v45, s44
    v_perm_b32 v127, v47, v45, s45
    v_perm_b32 v32, v50, v48, s44
    v_perm_b32 v36, v50, v48, s45
    v_perm_b32 v40, v51, v49, s44
    v_perm_b32 v44, v51, v49, s45
    v_perm_b32 v33, v54, v52, s44
    v_perm_b32 v37, v54, v52, s45
    v_perm_b32 v41, v55, v53, s44
    v_perm_b32 v45, v55, v53, s45
    v_perm_b32 v34, v58, v56, s44
    v_perm_b32 v38, v58, v56, s45
    v_perm_b32 v42, v59, v57, s44
    v_perm_b32 v46, v59, v57, s45
    v_perm_b32 v35, v62, v60, s44
    v_perm_b32 v39, v62, v60, s45
    v_perm_b32 v43, v63, v61, s44
    v_perm_b32 v47, v63, v61, s45
    s_cmp_ge_u32 s3, 8
    s_cbranch_scc1 L_fragdone
    v_perm_b32 v48, v66, v64, s44
    v_perm_b32 v52, v66, v64, s45
    v_perm_b32 v56, v67, v65, s44
    v_perm_b32 v60, v67, v65, s45
    v_perm_b32 v49, v70, v68, s44
    v_perm_b32 v53, v70, v68, s45
    v_perm_b32 v57, v71, v69, s44
    v_perm_b32 v61, v71, v69, s45
    v_perm_b32 v50, v74, v72, s44
    v_perm_b32 v54, v74, v72, s45
    v_perm_b32 v58, v75, v73, s44
    v_perm_b32 v62, v75, v73, s45
    v_perm_b32 v51, v78, v76, s44
    v_perm_b32 v55, v78, v76, s45
    v_perm_b32 v59, v79, v77, s44
    v_perm_b32 v63, v79, v77, s45
    v_perm_b32 v64, v82, v80, s44
    v_perm_b32 v68, v82, v80, s45
    v_perm_b32 v72, v83, v81, s44
    v_perm_b32 v76, v83, v81, s45
    v_perm_b32 v65, v86, v84, s44
    v_perm_b32 v69, v86, v84, s45
    v_perm_b32 v73, v87, v85, s44
    v_perm_b32 v77, v87, v85, s45
    v_perm_b32 v66, v90, v88, s44
    v_perm_b32 v70, v90, v88, s45
    v_perm_b32 v74, v91, v89, s44
    v_perm_b32 v78, v91, v89, s45
    v_perm_b32 v67, v94, v92, s44
    v_perm_b32 v71, v94, v92, s45
    v_perm_b32 v75, v95, v93, s44
    v_perm_b32 v79, v95, v93, s45
L_fragdone:
    v_mov_b32 v10, v18
    v_mov_b32 v11, v19
    v_mov_b32 v12, v20
    v_mov_b32 v13, v21
    v_permlane16_swap_b32 v18, v10
    v_permlane16_swap_b32 v19, v11
    v_permlane16_swap_b32 v20, v12
    v_permlane16_swap_b32 v21, v13
    v_add_f32 v18, v18, v10
    v_add_f32 v19, v19, v11
    v_add_f32 v20, v20, v12
    v_add_f32 v21, v21, v13
    v_mov_b32 v10, v18
    v_mov_b32 v11, v19
    v_mov_b32 v12, v20
    v_mov_b32 v13, v21
    v_permlane32_swap_b32 v18, v10
    v_permlane32_swap_b32 v19, v11
    v_permlane32_swap_b32 v20, v12
    v_permlane32_swap_b32 v21, v13
    v_add_f32 v18, v18, v10
    v_add_f32 v19, v19, v11
    v_add_f32 v20, v20, v12
    v_add_f32 v21, v21, v13
    v_mov_b32 v80, v18
    v_mov_b32 v81, 0
    v_mov_b32 v82, 0
    v_mov_b32 v83, 0
    v_mov_b32 v84, v19
    v_mov_b32 v85, 0
    v_mov_b32 v86, 0
    v_mov_b32 v87, 0
    v_mov_b32 v88, v20
    v_mov_b32 v89, 0
    v_mov_b32 v90, 0
    v_mov_b32 v91, 0
    v_mov_b32 v92, v21
    v_mov_b32 v93, 0
    v_mov_b32 v94, 0
    v_mov_b32 v95, 0
    v_and_b32 v6, 3, v3
    v_mul_u32_u24 v6, 272, v6
    v_lshl_add_u32 v6, v2, 6, v6
    s_cmp_ge_u32 s3, 10
    s_cselect_b32 s59, 32, 0
    v_add_u32 v6, s59, v6
    v_mov_b32 v7, s43
    s_and_b32 s59, s3, 1
    s_lshl_b32 s59, s59, 8
    v_lshl_add_u32 v9, v3, 4, s59
    s_cmp_lt_u32 s3, 8
    s_cbranch_scc1 L_pfull
    s_setprio 1
    s_waitcnt lgkmcnt(0)
    s_barrier
    ds_read_b128 v[96:99], v6 offset:8192
    ds_read_b128 v[100:103], v6 offset:8208
    s_branch L_mf_lo
L_pfull:
    s_waitcnt lgkmcnt(0)
    s_barrier
    ds_read_b128 v[104:107], v6 offset:8224
    ds_read_b128 v[108:111], v6 offset:8240
    ds_read_b128 v[96:99], v6 offset:8192
    ds_read_b128 v[100:103], v6 offset:8208
    s_waitcnt lgkmcnt(3)
    v_mfma_f32_16x16x32_bf16 v[80:83], v[104:107], v[48:51], v[80:83]
    v_mfma_f32_16x16x32_bf16 v[84:87], v[104:107], v[52:55], v[84:87]
    v_mfma_f32_16x16x32_bf16 v[88:91], v[104:107], v[56:59], v[88:91]
    v_mfma_f32_16x16x32_bf16 v[92:95], v[104:107], v[60:63], v[92:95]
    s_waitcnt lgkmcnt(2)
    v_mfma_f32_16x16x32_bf16 v[80:83], v[108:111], v[64:67], v[80:83]
    v_mfma_f32_16x16x32_bf16 v[84:87], v[108:111], v[68:71], v[84:87]
    v_mfma_f32_16x16x32_bf16 v[88:91], v[108:111], v[72:75], v[88:91]
    v_mfma_f32_16x16x32_bf16 v[92:95], v[108:111], v[76:79], v[92:95]
L_mf_lo:
    s_waitcnt lgkmcnt(1)
    v_mfma_f32_16x16x32_bf16 v[80:83], v[96:99], v[112:115], v[80:83]
    v_mfma_f32_16x16x32_bf16 v[84:87], v[96:99], v[116:119], v[84:87]
    v_mfma_f32_16x16x32_bf16 v[88:91], v[96:99], v[120:123], v[88:91]
    v_mfma_f32_16x16x32_bf16 v[92:95], v[96:99], v[124:127], v[92:95]
    s_waitcnt lgkmcnt(0)
    v_mfma_f32_16x16x32_bf16 v[80:83], v[100:103], v[32:35], v[80:83]
    v_mfma_f32_16x16x32_bf16 v[84:87], v[100:103], v[36:39], v[84:87]
    v_mfma_f32_16x16x32_bf16 v[88:91], v[100:103], v[40:43], v[88:91]
    v_mfma_f32_16x16x32_bf16 v[92:95], v[100:103], v[44:47], v[92:95]
    s_mov_b64 exec, 0xffff
    s_cmp_ge_u32 s3, 8
    s_cbranch_scc1 L_hm
    s_nop 1
    v_add_f32 v80, v80, v81
    v_add_f32 v82, v82, v83
    v_add_f32 v80, v80, v82
    v_and_or_b32 v18, v80, s42, v7
    v_add_f32 v84, v84, v85
    v_add_f32 v86, v86, v87
    v_add_f32 v84, v84, v86
    v_and_or_b32 v19, v84, s42, v7
    v_add_f32 v88, v88, v89
    v_add_f32 v90, v90, v91
    v_add_f32 v88, v88, v90
    v_and_or_b32 v20, v88, s42, v7
    v_add_f32 v92, v92, v93
    v_add_f32 v94, v94, v95
    v_add_f32 v92, v92, v94
    v_and_or_b32 v21, v92, s42, v7
L_ystore:
    buffer_store_dwordx4 v[18:21], v5, s[36:39], s53 offen sc1
    s_mov_b64 exec, -1
    s_branch L_noproj
L_hm:
    s_nop 1
    v_add_f32 v80, v80, v81
    v_add_f32 v82, v82, v83
    v_add_f32 v18, v80, v82
    v_add_f32 v84, v84, v85
    v_add_f32 v86, v86, v87
    v_add_f32 v19, v84, v86
    v_add_f32 v88, v88, v89
    v_add_f32 v90, v90, v91
    v_add_f32 v20, v88, v90
    v_add_f32 v92, v92, v93
    v_add_f32 v94, v94, v95
    v_add_f32 v21, v92, v94
    s_cmp_lt_u32 s3, 10
    s_cbranch_scc1 L_hm2
    ds_write_b128 v9, v[18:21] offset:9472
    ds_write_b32 v30, v22 offset:10760
    s_mov_b64 exec, -1
    s_branch L_noproj
L_hm2:
    ds_read_b32 v96, v30 offset:10768
    ds_read_b128 v[100:103], v9 offset:9472
    s_waitcnt lgkmcnt(0)
    v_readfirstlane_b32 s59, v96
    s_nop 0
    s_cmp_eq_u32 s59, 1
    s_cbranch_scc1 L_hm3
    s_sub_u32 s71, s71, 1
    s_cbranch_scc0 L_hm2
    s_endpgm
L_hm3:
    v_add_f32 v18, v18, v100
    v_add_f32 v19, v19, v101
    v_add_f32 v20, v20, v102
    v_add_f32 v21, v21, v103
    v_and_or_b32 v18, v18, s42, v7
    v_and_or_b32 v19, v19, s42, v7
    v_and_or_b32 v20, v20, s42, v7
    v_and_or_b32 v21, v21, s42, v7
    s_branch L_ystore
L_bar3:
    v_cvt_pk_bf16_f32 v24, v24, v25
    ds_write_b32 v31, v24 offset:4928
    s_waitcnt lgkmcnt(0)
    s_barrier
L_noproj:
    s_cmp_eq_u32 s56, -1
    s_cbranch_scc1 L_done
    s_mul_i32 s59, s54, 20
    s_add_u32 s59, s59, s56
    s_lshl_b32 s60, s59, 6
    s_lshl_b32 s59, s59, 14
    s_lshl_b32 s61, s3, 10
    s_add_u32 s59, s59, s61
    v_lshlrev_b32 v39, 4, v1
    v_and_b32 v40, 31, v1
    v_lshlrev_b32 v41, 1, v40
    buffer_load_ushort v42, v41, s[8:11], s60 offen
    v_and_b32 v37, 7, v3
    v_lshlrev_b32 v37, 4, v37
    v_lshl_add_u32 v37, v2, 2, v37
    s_lshl_b32 s61, s3, 7
    v_add_u32 v37, s61, v37
    v_lshrrev_b32 v38, 5, v1
    v_lshlrev_b32 v38, 10, v38
    v_lshl_add_u32 v38, v40, 2, v38
    v_mov_b32 v43, s69
L_polla:
    buffer_load_dwordx4 v[64:67], v39, s[36:39], s59 offen sc1
    s_waitcnt vmcnt(0)
    v_xor_b32 v64, s43, v64
    v_xor_b32 v65, s43, v65
    v_xor_b32 v66, s43, v66
    v_xor_b32 v67, s43, v67
    v_or3_b32 v36, v64, v65, v66
    v_or_b32 v36, v36, v67
    v_lshlrev_b32 v36, 24, v36
    v_cmp_ne_u32 vcc, 0, v36
    s_nop 0
    s_cmp_eq_u64 vcc, 0
    s_cbranch_scc1 L_polloka0
    s_sub_u32 s71, s71, 1
    s_cbranch_scc0 L_polla
    s_endpgm
L_polloka0:
    v_add_f32_dpp v32, v64, v64 row_ror:8 row_mask:0xf bank_mask:0xf
    v_add_f32_dpp v33, v65, v65 row_ror:8 row_mask:0xf bank_mask:0xf
    v_add_f32_dpp v34, v66, v66 row_ror:8 row_mask:0xf bank_mask:0xf
    v_add_f32_dpp v35, v67, v67 row_ror:8 row_mask:0xf bank_mask:0xf
    s_branch L_polldone
L_polldone:
    v_permlane32_swap_b32 v32, v34
    v_permlane32_swap_b32 v33, v35
    v_add_f32 v32, v32, v34
    v_add_f32 v33, v33, v35
    s_nop 1
    v_permlane16_swap_b32 v32, v33
    v_add_f32 v32, v32, v33
    ds_write_b32 v37, v32 offset:0
    v_lshlrev_b32 v42, 16, v42
    s_waitcnt lgkmcnt(0)
    s_barrier
    s_cmp_lg_u32 s3, 0
    s_cbranch_scc1 L_done
    ds_read_b32 v44, v38 offset:0
    ds_read_b32 v45, v38 offset:128
    ds_read_b32 v46, v38 offset:256
    ds_read_b32 v47, v38 offset:384
    ds_read_b32 v48, v38 offset:512
    ds_read_b32 v49, v38 offset:640
    ds_read_b32 v50, v38 offset:768
    ds_read_b32 v51, v38 offset:896
    s_waitcnt lgkmcnt(0)
    v_add_f32 v44, v44, v45
    v_add_f32 v46, v46, v47
    v_add_f32 v48, v48, v49
    v_add_f32 v50, v50, v51
    v_add_f32 v44, v44, v46
    v_add_f32 v48, v48, v50
    v_add_f32 v44, v44, v48
    v_mov_b32 v45, v44
    s_nop 1
    v_permlane32_swap_b32 v44, v45
    v_add_f32 v44, v44, v45
    v_add_f32 v44, v44, v42
    v_cvt_pk_bf16_f32 v44, v44, v44
    s_mov_b32 exec_hi, 0
    buffer_store_short v44, v41, s[32:35], s60 offen sc1
    s_cmp_lg_u32 s60, 0
    s_cbranch_scc1 L_done
    s_mov_b32 s61, 688128
    s_mov_b64 exec, 1
    buffer_store_dword v43, off, s[36:39], s61 sc1
L_done:
L_end:
    s_endpgm
.section .rodata,"a"
.p2align 6
.amdhsa_kernel parallel_sum__gqa_block_cached__geglu_ffn__decode_kernel
  .amdhsa_next_free_vgpr 128
  .amdhsa_next_free_sgpr 102
  .amdhsa_accum_offset 128
  .amdhsa_group_segment_fixed_size 0
  .amdhsa_kernarg_size 96
  .amdhsa_user_sgpr_count 2
  .amdhsa_user_sgpr_kernarg_segment_ptr 1
  .amdhsa_system_sgpr_workgroup_id_x 1
.end_amdhsa_kernel
```
